```python
import torch

def _softmax(x, axis=-1):
    return torch.softmax(x, dim=axis)
def _gelu(x):
    return torch.nn.functional.gelu(x, approximate="tanh")
def _silu(x):
    return torch.nn.functional.silu(x)
def _sigmoid(x):
    return torch.sigmoid(x)
def _layernorm(x, axis=-1, eps=1e-5):
    m = x.mean(dim=axis, keepdim=True)
    v = x.var(dim=axis, keepdim=True, unbiased=False)
    return (x - m) / torch.sqrt(v + eps)
def _scatter_add(tgt, idx, src, axis=0):
    return tgt.clone().index_add_(axis, idx, src)
def _segment_sum(src, seg, n):
    out = torch.zeros((n,) + src.shape[1:], dtype=src.dtype)
    return out.index_add_(0, seg, src)
def _pad(x, pw):
    flat = tuple(v for pair in reversed(pw) for v in pair)
    return torch.nn.functional.pad(x, flat)

kernel_name = 'recurrent_scan__grouped_kv_mqa__geglu_ffn__prompt'

def setup_inputs():

    _w = (lambda a: (lambda t: t.to(torch.bfloat16) if t.is_floating_point() else t)(torch.as_tensor(a)))
    def _A_setup():
        B, S, D, H = 1, 2048, 512, 32
        Dh = D // H
        return {
            "x": _w((lambda *s: torch.randn(*s, dtype=torch.bfloat16) * 0.05)(B, S, D)),
            "wq": _w((lambda *s: torch.randn(*s, dtype=torch.bfloat16) * 0.05)(D, H * Dh)),
            "wk": _w((lambda *s: torch.randn(*s, dtype=torch.bfloat16) * 0.05)(D, Dh)),
            "wv": _w((lambda *s: torch.randn(*s, dtype=torch.bfloat16) * 0.05)(D, Dh)),
            "wo": _w((lambda *s: torch.randn(*s, dtype=torch.bfloat16) * 0.05)(H * Dh, D)),
        }
    _A_in = _A_setup()

    def _B_setup():
        B, S, D, F = 1, 2048, 512, 1376
        return {
            "x": _w((lambda *s: torch.randn(*s, dtype=torch.bfloat16) * 0.05)(B, S, D)),
            "w_gate": _w((lambda *s: torch.randn(*s, dtype=torch.bfloat16) * 0.05)(D, F)),
            "w_up": _w((lambda *s: torch.randn(*s, dtype=torch.bfloat16) * 0.05)(D, F)),
            "w_down": _w((lambda *s: torch.randn(*s, dtype=torch.bfloat16) * 0.05)(F, D)),
        }
    _B_in = _B_setup()

    return {
        "A_x": _A_in["x"],
        "A_wq": _A_in["wq"],
        "A_wk": _A_in["wk"],
        "A_wv": _A_in["wv"],
        "A_wo": _A_in["wo"],
        "B_x": _B_in["x"],
        "B_w_gate": _B_in["w_gate"],
        "B_w_up": _B_in["w_up"],
        "B_w_down": _B_in["w_down"],
    }

def reference(A_x, A_wq, A_wk, A_wv, A_wo, B_x, B_w_gate, B_w_up, B_w_down):
    def _A_ref(x, wq, wk, wv, wo):
        B, S, D = x.shape
        H = 32
        Dh = D // H
        q = (lambda x, *d: x.permute(*d))((x @ wq).reshape(B, S, H, Dh), 0, 2, 1, 3)
        k = x @ wk
        v = x @ wv
        scores = torch.einsum("bhqd,bkd->bhqk", q, k) * (Dh ** -0.5)
        p = _softmax(scores, axis=-1)
        o = torch.einsum("bhqk,bkd->bhqd", p, v)
        return (lambda x, *d: x.permute(*d))(o, 0, 2, 1, 3).reshape(B, S, H * Dh) @ wo

    def _B_ref(x, w_gate, w_up, w_down):
        return (_gelu(x @ w_gate) * (x @ w_up)) @ w_down

    x = A_x
    xn = _layernorm(x, axis=-1)
    s = _A_ref(xn, A_wq, A_wk, A_wv, A_wo)
    g = _silu(_B_ref(xn, B_w_gate, B_w_up, B_w_down))
    return x + s * g
```

```asm
; @launch grid=(256,1,1) block=(512,1,1) lds=163840
.amdgcn_target "amdgcn-amd-amdhsa--gfx950"
.text
.globl recurrent_scan__grouped_kv_mqa__geglu_ffn__prompt_kernel
.p2align 8
.type recurrent_scan__grouped_kv_mqa__geglu_ffn__prompt_kernel,@function
recurrent_scan__grouped_kv_mqa__geglu_ffn__prompt_kernel:
    s_cmp_ge_u32 s2, 256
    s_cbranch_scc1 Lend
    s_load_dwordx2 s[4:5], s[0:1], 0
    s_load_dwordx2 s[24:25], s[0:1], 48
    s_load_dwordx2 s[8:9], s[0:1], 8
    s_load_dwordx2 s[16:17], s[0:1], 24
    s_load_dwordx2 s[36:37], s[0:1], 80
    s_load_dwordx2 s[40:41], s[0:1], 88
    v_and_b32 v1, 63, v0
    v_lshrrev_b32 v3, 6, v0
    v_lshrrev_b32 v2, 5, v1
    v_readfirstlane_b32 s46, v3
    s_cmp_lg_u32 s46, 7
    s_cbranch_scc1 Lnop0
    s_getpc_b64 s[94:95]
Lpc0:
    s_bfe_u32 s57, s2, 0x20003
    s_lshl_b32 s57, s57, 13
    v_lshl_add_u32 v4, v1, 7, s57
    v_min_u32 v4, Lcodeend-Lpc0-4, v4
    global_load_dword v236, v4, s[94:95]
Lnop0:
    s_and_b32 s57, s2, 7
    s_lshr_b32 s58, s2, 3
    s_and_b32 s44, s57, 1
    s_lshl_b32 s44, s44, 3
    s_and_b32 s59, s58, 7
    s_add_u32 s44, s44, s59
    s_lshr_b32 s45, s57, 1
    s_lshl_b32 s45, s45, 2
    s_lshr_b32 s60, s58, 3
    s_add_u32 s45, s45, s60
    s_sub_u32 s45, 15, s45
    s_and_b32 s61, s57, 3
    s_lshl_b32 s61, s61, 3
    s_add_u32 s61, s61, s59
    s_lshr_b32 s62, s57, 2
    s_lshl_b32 s62, s62, 2
    s_add_u32 s62, s62, s60
    s_and_b32 s47, s46, 3
    v_lshrrev_b32 v3, 3, v1
    v_lshlrev_b32 v3, 10, v3
    v_and_b32 v4, 7, v1
    v_lshrrev_b32 v5, 4, v1
    v_xor_b32 v4, v4, v5
    v_lshl_add_u32 v7, v4, 4, v3
    v_xor_b32 v8, 64, v7
    v_add_u32 v8, 7168, v8
    v_lshlrev_b32 v244, 4, v1
    s_lshl_b32 s48, s44, 17
    s_lshl_b32 s57, s47, 15
    s_add_u32 s48, s48, s57
    s_lshl_b32 s63, s44, 4
    s_add_u32 s63, s63, s45
    s_lshl_b32 s63, s63, 2
    s_add_u32 s63, s63, s47
    s_cmp_eq_u32 s45, 15
    s_cselect_b32 s57, 16, 56
    s_load_dwordx2 s[12:13], s[0:1], s57
    s_mov_b32 s58, 1409024
    s_cselect_b32 s14, 16384, s58
    s_mov_b32 s15, 0x20000
    s_mov_b32 s6, 2097152
    s_mov_b32 s7, 0x20000
    s_mov_b32 s26, 1409024
    s_mov_b32 s27, 0x20000
    s_mov_b32 s10, 524288
    s_mov_b32 s11, 0x20000
    s_mov_b32 s18, 16384
    s_mov_b32 s19, 0x20000
    s_mov_b32 s38, 256
    s_mov_b32 s39, 0x20000
    s_mov_b32 s42, 8722432
    s_mov_b32 s43, 0x20000
    s_cbranch_scc1 Lkv0
    s_cmp_lt_u32 s46, 4
    s_cbranch_scc1 Lhelp
    s_waitcnt lgkmcnt(0)
    s_lshl_b32 s58, s63, 11
    buffer_load_dwordx4 v[144:147], v244, s[4:7], s58 offen
    buffer_load_dwordx4 v[148:151], v244, s[4:7], s58 offen offset:1024
    s_cmp_lg_u32 s45, 14
    s_cbranch_scc1 Lcomp
    s_add_u32 s58, s58, 8192
    buffer_load_dwordx4 v[216:219], v244, s[4:7], s58 offen
    buffer_load_dwordx4 v[220:223], v244, s[4:7], s58 offen offset:1024
    s_branch Lcomp
Lkv0:
    s_memrealtime s[90:91]
    s_lshl_b32 s53, s46, 14
    s_lshr_b32 s60, s46, 2
    s_lshl_b32 s57, s60, 9
    s_add_u32 s48, s48, s57
    s_or_b32 s57, s2, s46
    s_cmp_lg_u32 s57, 0
    s_waitcnt lgkmcnt(0)
    s_cbranch_scc1 Lnotag
    s_or_b32 s90, s90, 1
    v_mov_b32 v246, s90
    v_mov_b32 v247, s91
    s_mov_b64 exec, 1
    buffer_store_dwordx2 v[246:247], off, s[36:39], 0 sc1
    s_mov_b64 exec, -1
Lnotag:
    s_lshl_b32 s57, s46, 11
    s_add_u32 m0, s57, 131072
    s_nop 0
    buffer_load_dwordx4 v244, s[16:19], s57 offen lds
    buffer_load_dwordx4 v244, s[16:19], s57 offen offset:1024 lds
    s_add_u32 m0, s57, 147456
    s_nop 0
    buffer_load_dwordx4 v244, s[12:15], s57 offen lds
    buffer_load_dwordx4 v244, s[12:15], s57 offen offset:1024 lds
    s_add_u32 m0, s53, 0
    s_add_u32 s57, s48, 0
    buffer_load_dwordx4 v7, s[4:7], s57 offen lds
    buffer_load_dwordx4 v8, s[4:7], s57 offen offset:1024 lds
    s_add_u32 m0, s53, 2048
    s_add_u32 s57, s48, 16384
    buffer_load_dwordx4 v7, s[4:7], s57 offen lds
    buffer_load_dwordx4 v8, s[4:7], s57 offen offset:1024 lds
    s_branch Lkvcu
Lhelp:
    s_mov_b32 s51, 0
    s_lshl_b32 s52, s47, 12
    s_xor_b32 s84, s44, s45
    s_and_b32 s84, s84, 1
    s_lshl_b32 s84, s84, 2
    s_lshr_b32 s57, s44, 1
    s_xor_b32 s57, s57, s45
    s_lshr_b32 s57, s57, 1
    s_and_b32 s57, s57, 2
    s_or_b32 s84, s84, s57
    s_lshl_b32 s57, s84, 7
    s_add_u32 s48, s48, s57
    s_lshl_b32 s69, s45, 13
    s_add_u32 s69, s69, 8067072
    s_lshl_b32 s95, s84, 10
    s_add_u32 s95, s95, s69
    s_cmp_eq_u32 s45, 14
    s_cselect_b32 s60, 8, 0
    v_mov_b32 v6, 0x40000000
    v_add_u32 v3, 0, v1
    v_mul_u32_u24 v4, 43691, v3
    v_lshrrev_b32 v4, 19, v4
    v_mul_u32_u24 v5, 12, v4
    v_sub_u32 v3, v3, v5
    v_lshrrev_b32 v5, 2, v4
    v_and_b32 v5, 2, v5
    v_xor_b32 v3, v3, v5
    v_mul_u32_u24 v4, 2752, v4
    v_lshl_add_u32 v9, v3, 4, v4
    v_cmp_gt_u32 vcc, s60, v3
    s_nop 1
    v_cndmask_b32 v9, v9, v6, vcc
    v_add_u32 v3, 64, v1
    v_mul_u32_u24 v4, 43691, v3
    v_lshrrev_b32 v4, 19, v4
    v_mul_u32_u24 v5, 12, v4
    v_sub_u32 v3, v3, v5
    v_lshrrev_b32 v5, 2, v4
    v_and_b32 v5, 2, v5
    v_xor_b32 v3, v3, v5
    v_mul_u32_u24 v4, 2752, v4
    v_lshl_add_u32 v10, v3, 4, v4
    v_cmp_gt_u32 vcc, s60, v3
    v_subrev_u32 v10, 1024, v10
    s_nop 1
    v_cndmask_b32 v10, v10, v6, vcc
    v_add_u32 v3, 128, v1
    v_mul_u32_u24 v4, 43691, v3
    v_lshrrev_b32 v4, 19, v4
    v_mul_u32_u24 v5, 12, v4
    v_sub_u32 v3, v3, v5
    v_lshrrev_b32 v5, 2, v4
    v_and_b32 v5, 2, v5
    v_xor_b32 v3, v3, v5
    v_mul_u32_u24 v4, 2752, v4
    v_lshl_add_u32 v11, v3, 4, v4
    v_cmp_gt_u32 vcc, s60, v3
    v_subrev_u32 v11, 2048, v11
    s_nop 1
    v_cndmask_b32 v11, v11, v6, vcc
    v_lshrrev_b32 v3, 2, v1
    v_lshlrev_b32 v3, 10, v3
    v_and_b32 v4, 3, v1
    v_lshlrev_b32 v5, 1, v2
    v_xor_b32 v4, v4, v5
    v_lshl_add_u32 v12, v4, 4, v3
    s_mul_i32 s57, s45, 96
    s_min_u32 s57, s57, 1280
    s_lshl_b32 s57, s57, 1
    s_mul_i32 s49, s47, 44032
    s_add_u32 s49, s49, s57
    s_lshl_b32 s50, s47, 14
    s_lshl_b32 s57, s45, 6
    s_add_u32 s50, s50, s57
    s_mul_i32 s53, s47, 3072
    s_add_u32 s53, s53, 16384
    s_lshl_b32 s54, s47, 10
    s_add_u32 s54, s54, 40960
    s_mul_i32 s57, s84, 176128
    s_add_u32 s49, s49, s57
    s_lshl_b32 s57, s84, 16
    s_add_u32 s50, s50, s57
    s_lshl_b32 s57, s47, 15
    s_sub_u32 s48, s48, s57
    s_sub_u32 s60, 4, s47
    s_mul_i32 s57, s60, 44032
    s_sub_u32 s49, s49, s57
    s_lshl_b32 s57, s60, 14
    s_sub_u32 s50, s50, s57
    s_mul_i32 s57, s60, 3072
    s_sub_u32 s53, s53, s57
    s_lshl_b32 s57, s60, 10
    s_sub_u32 s54, s54, s57
    s_add_u32 s52, s54, 1024
    s_waitcnt lgkmcnt(0)
    s_cmp_lt_u32 s46, 2
    s_cbranch_scc1 Lhx
    s_add_u32 s58, s51, s53
    s_add_u32 s59, s49, 44032
    s_add_u32 m0, s58, 0
    s_nop 0
    buffer_load_dwordx4 v9, s[24:27], s49 offen lds
    buffer_load_dwordx4 v10, s[24:27], s49 offen offset:1024 lds
    buffer_load_dwordx4 v11, s[24:27], s49 offen offset:2048 lds
    s_add_u32 m0, s58, 12288
    s_nop 0
    buffer_load_dwordx4 v9, s[12:15], s49 offen lds
    buffer_load_dwordx4 v10, s[12:15], s49 offen offset:1024 lds
    buffer_load_dwordx4 v11, s[12:15], s49 offen offset:2048 lds
    s_add_u32 m0, s51, s54
    s_add_u32 s57, s50, 0
    buffer_load_dwordx4 v12, s[8:11], s57 offen lds
    s_add_u32 m0, s58, 3072
    s_nop 0
    buffer_load_dwordx4 v9, s[24:27], s59 offen lds
    buffer_load_dwordx4 v10, s[24:27], s59 offen offset:1024 lds
    buffer_load_dwordx4 v11, s[24:27], s59 offen offset:2048 lds
    s_add_u32 m0, s58, 15360
    s_nop 0
    buffer_load_dwordx4 v9, s[12:15], s59 offen lds
    buffer_load_dwordx4 v10, s[12:15], s59 offen offset:1024 lds
    buffer_load_dwordx4 v11, s[12:15], s59 offen offset:2048 lds
    s_add_u32 m0, s51, s52
    s_add_u32 s57, s50, 16384
    buffer_load_dwordx4 v12, s[8:11], s57 offen lds
    s_add_u32 s51, s51, 45056
    s_cmp_ge_u32 s51, 135168
    s_cselect_b32 s51, 0, s51
    s_add_u32 s84, s84, 1
    s_cmp_eq_u32 s84, 8
    s_cselect_b32 s58, 1409024, 0
    s_cselect_b32 s59, 524288, 0
    s_add_u32 s49, s49, 176128
    s_add_u32 s50, s50, 65536
    s_sub_u32 s49, s49, s58
    s_sub_u32 s50, s50, s59
    s_add_u32 s58, s51, s53
    s_add_u32 s59, s49, 44032
    s_add_u32 m0, s58, 0
    s_nop 0
    buffer_load_dwordx4 v9, s[24:27], s49 offen lds
    buffer_load_dwordx4 v10, s[24:27], s49 offen offset:1024 lds
    buffer_load_dwordx4 v11, s[24:27], s49 offen offset:2048 lds
    s_add_u32 m0, s58, 12288
    s_nop 0
    buffer_load_dwordx4 v9, s[12:15], s49 offen lds
    buffer_load_dwordx4 v10, s[12:15], s49 offen offset:1024 lds
    buffer_load_dwordx4 v11, s[12:15], s49 offen offset:2048 lds
    s_add_u32 m0, s51, s54
    s_add_u32 s57, s50, 0
    buffer_load_dwordx4 v12, s[8:11], s57 offen lds
    s_add_u32 m0, s58, 3072
    s_nop 0
    buffer_load_dwordx4 v9, s[24:27], s59 offen lds
    buffer_load_dwordx4 v10, s[24:27], s59 offen offset:1024 lds
    buffer_load_dwordx4 v11, s[24:27], s59 offen offset:2048 lds
    s_add_u32 m0, s58, 15360
    s_nop 0
    buffer_load_dwordx4 v9, s[12:15], s59 offen lds
    buffer_load_dwordx4 v10, s[12:15], s59 offen offset:1024 lds
    buffer_load_dwordx4 v11, s[12:15], s59 offen offset:2048 lds
    s_add_u32 m0, s51, s52
    s_add_u32 s57, s50, 16384
    buffer_load_dwordx4 v12, s[8:11], s57 offen lds
    s_add_u32 s51, s51, 45056
    s_cmp_ge_u32 s51, 135168
    s_cselect_b32 s51, 0, s51
    s_add_u32 s84, s84, 1
    s_cmp_eq_u32 s84, 8
    s_cselect_b32 s58, 1409024, 0
    s_cselect_b32 s59, 524288, 0
    s_add_u32 s49, s49, 176128
    s_add_u32 s50, s50, 65536
    s_sub_u32 s49, s49, s58
    s_sub_u32 s50, s50, s59
    s_load_dwordx2 s[32:33], s[0:1], 72
    s_mov_b32 s34, 2097152
    s_mov_b32 s35, 0x20000
    s_lshl_b32 s57, s47, 2
    s_add_u32 s57, s57, 163776
    v_mov_b32 v30, s57
    v_mov_b32 v31, 0
    v_mov_b32 v3, 163776
    ds_write_b32 v30, v31
    ds_write_b32 v3, v31 offset:16
    s_mov_b32 s55, 0
    s_waitcnt vmcnt(14) lgkmcnt(0)
    s_barrier
Lhlw:
    s_add_u32 s58, s51, s53
    s_add_u32 s59, s49, 44032
    s_add_u32 m0, s58, 0
    s_nop 0
    buffer_load_dwordx4 v9, s[24:27], s49 offen lds
    buffer_load_dwordx4 v10, s[24:27], s49 offen offset:1024 lds
    buffer_load_dwordx4 v11, s[24:27], s49 offen offset:2048 lds
    s_add_u32 m0, s58, 12288
    s_nop 0
    buffer_load_dwordx4 v9, s[12:15], s49 offen lds
    buffer_load_dwordx4 v10, s[12:15], s49 offen offset:1024 lds
    buffer_load_dwordx4 v11, s[12:15], s49 offen offset:2048 lds
    s_add_u32 m0, s51, s54
    s_add_u32 s57, s50, 0
    buffer_load_dwordx4 v12, s[8:11], s57 offen lds
    s_add_u32 m0, s58, 3072
    s_nop 0
    buffer_load_dwordx4 v9, s[24:27], s59 offen lds
    buffer_load_dwordx4 v10, s[24:27], s59 offen offset:1024 lds
    buffer_load_dwordx4 v11, s[24:27], s59 offen offset:2048 lds
    s_add_u32 m0, s58, 15360
    s_nop 0
    buffer_load_dwordx4 v9, s[12:15], s59 offen lds
    buffer_load_dwordx4 v10, s[12:15], s59 offen offset:1024 lds
    buffer_load_dwordx4 v11, s[12:15], s59 offen offset:2048 lds
    s_add_u32 m0, s51, s52
    s_add_u32 s57, s50, 16384
    buffer_load_dwordx4 v12, s[8:11], s57 offen lds
    s_add_u32 s51, s51, 45056
    s_cmp_ge_u32 s51, 135168
    s_cselect_b32 s51, 0, s51
    s_add_u32 s84, s84, 1
    s_cmp_eq_u32 s84, 8
    s_cselect_b32 s58, 1409024, 0
    s_cselect_b32 s59, 524288, 0
    s_add_u32 s49, s49, 176128
    s_add_u32 s50, s50, 65536
    s_sub_u32 s49, s49, s58
    s_sub_u32 s50, s50, s59
    s_add_u32 s55, s55, 1
    s_waitcnt vmcnt(14)
    s_barrier
    s_cmp_lt_u32 s55, 6
    s_cbranch_scc1 Lhlw
    s_branch Lh6
Lhx:
    s_cmp_eq_u32 s46, 0
    s_cbranch_scc1 Lh0
    s_add_u32 m0, s51, 0
    s_add_u32 s57, s48, 0
    buffer_load_dwordx4 v7, s[4:7], s57 offen lds
    buffer_load_dwordx4 v8, s[4:7], s57 offen offset:1024 lds
    s_add_u32 m0, s51, 2048
    s_add_u32 s57, s48, 16384
    buffer_load_dwordx4 v7, s[4:7], s57 offen lds
    buffer_load_dwordx4 v8, s[4:7], s57 offen offset:1024 lds
    s_add_u32 m0, s51, 4096
    s_add_u32 s57, s48, 32768
    buffer_load_dwordx4 v7, s[4:7], s57 offen lds
    buffer_load_dwordx4 v8, s[4:7], s57 offen offset:1024 lds
    s_add_u32 m0, s51, 6144
    s_add_u32 s57, s48, 49152
    buffer_load_dwordx4 v7, s[4:7], s57 offen lds
    buffer_load_dwordx4 v8, s[4:7], s57 offen offset:1024 lds
    s_add_u32 m0, s51, 8192
    s_add_u32 s57, s48, 65536
    buffer_load_dwordx4 v7, s[4:7], s57 offen lds
    buffer_load_dwordx4 v8, s[4:7], s57 offen offset:1024 lds
    s_add_u32 m0, s51, 10240
    s_add_u32 s57, s48, 81920
    buffer_load_dwordx4 v7, s[4:7], s57 offen lds
    buffer_load_dwordx4 v8, s[4:7], s57 offen offset:1024 lds
    s_add_u32 m0, s51, 12288
    s_add_u32 s57, s48, 98304
    buffer_load_dwordx4 v7, s[4:7], s57 offen lds
    buffer_load_dwordx4 v8, s[4:7], s57 offen offset:1024 lds
    s_add_u32 m0, s51, 14336
    s_add_u32 s57, s48, 114688
    buffer_load_dwordx4 v7, s[4:7], s57 offen lds
    buffer_load_dwordx4 v8, s[4:7], s57 offen offset:1024 lds
    s_add_u32 s51, s51, 45056
    s_cmp_ge_u32 s51, 135168
    s_cselect_b32 s51, 0, s51
    s_add_u32 s84, s84, 1
    s_cmp_eq_u32 s84, 8
    s_cselect_b32 s57, 1024, 0
    s_add_u32 s48, s48, 128
    s_sub_u32 s48, s48, s57
    s_add_u32 m0, s51, 0
    s_add_u32 s57, s48, 0
    buffer_load_dwordx4 v7, s[4:7], s57 offen lds
    buffer_load_dwordx4 v8, s[4:7], s57 offen offset:1024 lds
    s_add_u32 m0, s51, 2048
    s_add_u32 s57, s48, 16384
    buffer_load_dwordx4 v7, s[4:7], s57 offen lds
    buffer_load_dwordx4 v8, s[4:7], s57 offen offset:1024 lds
    s_add_u32 m0, s51, 4096
    s_add_u32 s57, s48, 32768
    buffer_load_dwordx4 v7, s[4:7], s57 offen lds
    buffer_load_dwordx4 v8, s[4:7], s57 offen offset:1024 lds
    s_add_u32 m0, s51, 6144
    s_add_u32 s57, s48, 49152
    buffer_load_dwordx4 v7, s[4:7], s57 offen lds
    buffer_load_dwordx4 v8, s[4:7], s57 offen offset:1024 lds
    s_add_u32 m0, s51, 8192
    s_add_u32 s57, s48, 65536
    buffer_load_dwordx4 v7, s[4:7], s57 offen lds
    buffer_load_dwordx4 v8, s[4:7], s57 offen offset:1024 lds
    s_add_u32 m0, s51, 10240
    s_add_u32 s57, s48, 81920
    buffer_load_dwordx4 v7, s[4:7], s57 offen lds
    buffer_load_dwordx4 v8, s[4:7], s57 offen offset:1024 lds
    s_add_u32 m0, s51, 12288
    s_add_u32 s57, s48, 98304
    buffer_load_dwordx4 v7, s[4:7], s57 offen lds
    buffer_load_dwordx4 v8, s[4:7], s57 offen offset:1024 lds
    s_add_u32 m0, s51, 14336
    s_add_u32 s57, s48, 114688
    buffer_load_dwordx4 v7, s[4:7], s57 offen lds
    buffer_load_dwordx4 v8, s[4:7], s57 offen offset:1024 lds
    s_add_u32 s51, s51, 45056
    s_cmp_ge_u32 s51, 135168
    s_cselect_b32 s51, 0, s51
    s_add_u32 s84, s84, 1
    s_cmp_eq_u32 s84, 8
    s_cselect_b32 s57, 1024, 0
    s_add_u32 s48, s48, 128
    s_sub_u32 s48, s48, s57
    s_load_dwordx2 s[32:33], s[0:1], 72
    s_mov_b32 s34, 2097152
    s_mov_b32 s35, 0x20000
    s_lshl_b32 s57, s47, 2
    s_add_u32 s57, s57, 163776
    v_mov_b32 v30, s57
    v_mov_b32 v31, 0
    v_mov_b32 v3, 163776
    ds_write_b32 v30, v31
    ds_write_b32 v3, v31 offset:16
    s_mov_b32 s55, 0
    s_waitcnt vmcnt(16) lgkmcnt(0)
    s_barrier
Lhlx:
    s_add_u32 m0, s51, 0
    s_add_u32 s57, s48, 0
    buffer_load_dwordx4 v7, s[4:7], s57 offen lds
    buffer_load_dwordx4 v8, s[4:7], s57 offen offset:1024 lds
    s_add_u32 m0, s51, 2048
    s_add_u32 s57, s48, 16384
    buffer_load_dwordx4 v7, s[4:7], s57 offen lds
    buffer_load_dwordx4 v8, s[4:7], s57 offen offset:1024 lds
    s_add_u32 m0, s51, 4096
    s_add_u32 s57, s48, 32768
    buffer_load_dwordx4 v7, s[4:7], s57 offen lds
    buffer_load_dwordx4 v8, s[4:7], s57 offen offset:1024 lds
    s_add_u32 m0, s51, 6144
    s_add_u32 s57, s48, 49152
    buffer_load_dwordx4 v7, s[4:7], s57 offen lds
    buffer_load_dwordx4 v8, s[4:7], s57 offen offset:1024 lds
    s_add_u32 m0, s51, 8192
    s_add_u32 s57, s48, 65536
    buffer_load_dwordx4 v7, s[4:7], s57 offen lds
    buffer_load_dwordx4 v8, s[4:7], s57 offen offset:1024 lds
    s_add_u32 m0, s51, 10240
    s_add_u32 s57, s48, 81920
    buffer_load_dwordx4 v7, s[4:7], s57 offen lds
    buffer_load_dwordx4 v8, s[4:7], s57 offen offset:1024 lds
    s_add_u32 m0, s51, 12288
    s_add_u32 s57, s48, 98304
    buffer_load_dwordx4 v7, s[4:7], s57 offen lds
    buffer_load_dwordx4 v8, s[4:7], s57 offen offset:1024 lds
    s_add_u32 m0, s51, 14336
    s_add_u32 s57, s48, 114688
    buffer_load_dwordx4 v7, s[4:7], s57 offen lds
    buffer_load_dwordx4 v8, s[4:7], s57 offen offset:1024 lds
    s_add_u32 s51, s51, 45056
    s_cmp_ge_u32 s51, 135168
    s_cselect_b32 s51, 0, s51
    s_add_u32 s84, s84, 1
    s_cmp_eq_u32 s84, 8
    s_cselect_b32 s57, 1024, 0
    s_add_u32 s48, s48, 128
    s_sub_u32 s48, s48, s57
    s_add_u32 s55, s55, 1
    s_waitcnt vmcnt(16)
    s_barrier
    s_cmp_lt_u32 s55, 6
    s_cbranch_scc1 Lhlx
    s_branch Lh6
Lh0:
    buffer_load_dwordx2 v[246:247], off, s[36:39], 0 sc1
    s_load_dwordx2 s[32:33], s[0:1], 72
    s_mov_b32 s34, 2097152
    s_mov_b32 s35, 0x20000
    s_lshl_b32 s57, s47, 2
    s_add_u32 s57, s57, 163776
    v_mov_b32 v30, s57
    v_mov_b32 v31, 0
    v_mov_b32 v3, 163776
    ds_write_b32 v30, v31
    ds_write_b32 v3, v31 offset:16
    s_mov_b32 s55, 0
    s_waitcnt lgkmcnt(0)
    s_barrier
    v_lshlrev_b32 v3, 3, v1
    v_add_u32 v3, 162816, v3
    ds_read_b64 v[32:33], v3
    s_mov_b32 s57, 0
    s_waitcnt vmcnt(0)
Ltag_p:
    v_readfirstlane_b32 s86, v246
    v_readfirstlane_b32 s87, v247
    s_add_u32 s57, s57, 1
    s_memrealtime s[90:91]
    s_waitcnt lgkmcnt(0)
    s_sub_u32 s90, s90, s86
    s_add_u32 s90, s90, 200
    s_cmp_lt_u32 s90, 2000
    s_cselect_b32 s90, 99, s57
    s_cmp_lt_u32 s90, 40
    s_cbranch_scc1 Ltagr_p
    s_cmp_lg_u32 s86, 0
    s_cbranch_scc1 Ltagd_p
    s_cmp_ge_u32 s57, 100000
    s_cbranch_scc1 Ltagd_p
Ltagr_p:
    s_sleep 1
    buffer_load_dwordx2 v[246:247], off, s[36:39], 0 sc1
    s_waitcnt vmcnt(0)
    s_branch Ltag_p
Ltagd_p:
    v_mov_b32 v34, s86
    v_mov_b32 v35, s87
    s_lshl_b32 s57, s63, 5
    s_add_u32 s57, s57, 8034304
    s_cmp_eq_u32 s45, 14
    s_mov_b32 exec_hi, 0
    s_mov_b32 exec_lo, 0xff
    s_cselect_b32 exec_lo, 0xffff, exec_lo
    s_waitcnt lgkmcnt(0)
    buffer_store_dwordx4 v[32:35], v244, s[40:43], s57 offen sc1
    s_mov_b64 exec, -1
    s_barrier
    s_barrier
    s_barrier
    s_and_b32 s57, s44, 6
    s_cmp_lg_u32 s57, 0
    s_cbranch_scc1 Lnpc
    ds_read_b64 v[40:41], v3
    ds_read_b64 v[36:37], v3 offset:512
    v_mov_b32 v42, s86
    v_mov_b32 v43, s87
    v_mov_b32 v38, s86
    v_mov_b32 v39, s87
    s_waitcnt lgkmcnt(0)
    buffer_store_dwordx4 v[40:43], v244, s[40:43], s95 offen sc1
    buffer_store_dwordx4 v[36:39], v244, s[40:43], s95 offen offset:1024 sc1
Lnpc:
    s_barrier
    s_barrier
    s_barrier
Lh6:
    s_lshl_b32 s94, s44, 11
    s_add_u32 s94, s94, 8034304
    s_mov_b32 s85, 8032256
    v_mov_b32 v31, 1
    buffer_load_dwordx2 v[246:247], off, s[36:39], 0 sc1
    s_cmp_lg_u32 s46, 1
    s_cbranch_scc1 Lhn0
    buffer_load_dwordx4 v[32:35], v244, s[40:43], s94 offen sc1
    buffer_load_dwordx4 v[36:39], v244, s[40:43], s94 offen offset:1024 sc1
Lhn0:
    s_lshl_b32 s57, s44, 2
    s_add_u32 s57, s57, s47
    s_lshl_b32 s57, s57, 5
    s_lshr_b32 s58, s45, 1
    s_add_u32 s57, s57, s58
    s_and_b32 s58, s45, 1
    s_lshl_b32 s58, s58, 4
    s_add_u32 s57, s57, s58
    s_lshl_b32 s57, s57, 10
    s_add_u32 s98, s57, 5902336
    s_add_u32 s99, s98, 8192
    v_and_b32 v242, 15, v1
    v_lshlrev_b32 v242, 4, v242
    v_lshl_add_u32 v242, v2, 8, v242
    s_mov_b32 exec_lo, 0xffff0000
    s_mov_b32 exec_hi, 0xffff0000
    v_mov_b32 v242, 512
    s_mov_b32 exec_lo, 0xffee0000
    s_mov_b32 exec_hi, 0xffee0000
    v_mov_b32 v242, 0x4000000
    s_mov_b64 exec, -1
    v_add_u32 v242, 1024, v242
    v_mov_b32 v241, v244
    v_mov_b32 v240, 0xdddd
    s_lshl_b32 s57, s47, 11
    s_add_u32 s57, s57, 135168
    v_add_u32 v237, s57, v244
    v_mov_b64 v[104:105], 0
    v_mov_b64 v[106:107], 0
    v_mov_b64 v[108:109], 0
    v_mov_b64 v[110:111], 0
    v_mov_b64 v[112:113], 0
    v_mov_b64 v[114:115], 0
    v_mov_b64 v[120:121], 0
    v_mov_b64 v[122:123], 0
    v_mov_b64 v[124:125], 0
    v_mov_b64 v[126:127], 0
    v_mov_b64 v[128:129], 0
    v_mov_b64 v[130:131], 0
    s_lshl_b32 s57, s61, 16
    s_lshl_b32 s58, s62, 7
    s_add_u32 s57, s57, s58
    s_lshl_b32 s58, s47, 14
    s_add_u32 s70, s57, s58
    s_add_u32 s64, s70, 8192
    v_lshrrev_b32 v3, 3, v1
    v_and_b32 v4, 7, v1
    v_lshlrev_b32 v245, 10, v3
    v_lshl_add_u32 v245, v4, 4, v245
    v_bfe_u32 v4, v1, 1, 2
    v_mul_u32_u24 v4, 8512, v4
    v_lshl_add_u32 v3, v3, 4, v4
    v_and_b32 v4, 1, v1
    v_mul_u32_u24 v4, 1056, v4
    s_and_b32 s57, s47, 1
    s_lshl_b32 s57, s57, 8
    v_add3_u32 v3, v3, v4, s57
    s_lshr_b32 s57, s47, 1
    s_mul_i32 s58, s57, 34048
    s_add_u32 s58, s58, 34048
    v_add_u32 v253, s58, v3
    s_mul_i32 s58, s57, 102144
    v_add_u32 v254, s58, v3
    s_mov_b32 s57, 0
    s_waitcnt vmcnt(0)
Ltag_h:
    v_readfirstlane_b32 s86, v246
    v_readfirstlane_b32 s87, v247
    s_add_u32 s57, s57, 1
    s_cmp_lg_u32 s86, 0
    s_cbranch_scc1 Ltagd_h
    s_cmp_ge_u32 s57, 100000
    s_cbranch_scc1 Ltagd_h
Ltagr_h:
    s_sleep 1
    buffer_load_dwordx2 v[246:247], off, s[36:39], 0 sc1
    s_waitcnt vmcnt(0)
    s_branch Ltag_h
Ltagd_h:
    s_cmp_lg_u32 s46, 1
    s_cbranch_scc1 Lhns
    s_mov_b32 s57, 0
    s_branch Lhs1
Lhs:
    buffer_load_dwordx4 v[32:35], v244, s[40:43], s94 offen sc1
    buffer_load_dwordx4 v[36:39], v244, s[40:43], s94 offen offset:1024 sc1
    s_waitcnt vmcnt(0)
Lhs1:
    s_add_u32 s57, s57, 1
    v_cmp_ne_u64 vcc, s[86:87], v[34:35]
    v_cmp_ne_u64 s[88:89], s[86:87], v[38:39]
    s_or_b64 vcc, vcc, s[88:89]
    s_cmp_ge_u32 s57, 100000
    s_cbranch_scc1 Lhns
    s_cbranch_vccnz Lhs
Lhns:
    s_cmp_lt_u32 s46, 2
    s_cbranch_scc1 Lhc0
    s_and_b32 s57, s46, 1
    s_lshl_b32 s57, s57, 10
    s_add_u32 s69, s69, s57
    s_add_u32 s95, s69, 4096
    buffer_load_dwordx4 v[32:35], v244, s[40:43], s69 offen offset:0 sc1
    buffer_load_dwordx4 v[36:39], v244, s[40:43], s69 offen offset:2048 sc1
    buffer_load_dwordx4 v[40:43], v244, s[40:43], s95 offen offset:0 sc1
    buffer_load_dwordx4 v[44:47], v244, s[40:43], s95 offen offset:2048 sc1
Lhc0:
    s_mov_b32 s55, 1
    s_barrier
    v_and_b32 v246, 15, v1
    v_lshlrev_b32 v246, 7, v246
    buffer_load_dwordx2 v[246:247], v246, s[40:43], s85 offen sc1
    s_cmp_lg_u32 s46, 1
    s_cbranch_scc1 Lhnc
    v_sub_f32 v40, 0, v32
    v_mul_f32 v43, v33, v33
    v_mul_f32 v41, 0xc0135761, v33
    v_mul_f32 v42, 0xbdd2d3e8, v33
    v_mul_f32 v42, v42, v43
    v_rcp_f32 v43, v43
    v_sub_f32 v44, 0, v36
    v_mul_f32 v47, v37, v37
    v_mul_f32 v45, 0xc0135761, v37
    v_mul_f32 v46, 0xbdd2d3e8, v37
    v_mul_f32 v46, v46, v47
    v_rcp_f32 v47, v47
    v_add_u32 v3, 160768, v244
    ds_write_b128 v3, v[40:43]
    ds_write_b128 v3, v[44:47] offset:1024
Lhnc:
    s_cmp_eq_u32 s55, 0
    s_cbranch_scc1 Lkt2_a
    s_waitcnt vmcnt(0)
    v_cmp_ne_u64 vcc, s[86:87], v[246:247]
    s_cbranch_vccnz Lkt1_a
    s_mul_i32 s58, s47, 3072
    s_add_u32 s57, s58, 0
    s_mov_b32 m0, s57
    s_nop 0
    buffer_load_dwordx4 v244, s[40:43], s57 offen offset:0 sc1 lds
    buffer_load_dwordx4 v244, s[40:43], s57 offen offset:1024 sc1 lds
    buffer_load_dwordx4 v244, s[40:43], s57 offen offset:2048 sc1 lds
    s_add_u32 s57, s58, 12288
    s_mov_b32 m0, s57
    s_nop 0
    buffer_load_dwordx4 v244, s[40:43], s57 offen offset:0 sc1 lds
    buffer_load_dwordx4 v244, s[40:43], s57 offen offset:1024 sc1 lds
    buffer_load_dwordx4 v244, s[40:43], s57 offen offset:2048 sc1 lds
    s_add_u32 s57, s58, 24576
    s_mov_b32 m0, s57
    s_nop 0
    buffer_load_dwordx4 v244, s[40:43], s57 offen offset:0 sc1 lds
    buffer_load_dwordx4 v244, s[40:43], s57 offen offset:1024 sc1 lds
    buffer_load_dwordx4 v244, s[40:43], s57 offen offset:2048 sc1 lds
    v_mov_b32 v3, 163776
    ds_write_b32 v3, v31 offset:16
    s_mov_b32 s55, 0
    s_branch Lkt2_a
Lkt1_a:
    v_and_b32 v246, 15, v1
    v_lshlrev_b32 v246, 7, v246
    buffer_load_dwordx2 v[246:247], v246, s[40:43], s85 offen sc1
Lkt2_a:
    s_cmp_lt_u32 s46, 2
    s_cbranch_scc1 Lhc3
    s_mov_b32 s57, 0
    s_branch Lhc2
Lhc1:
    s_sleep 2
    buffer_load_dwordx4 v[32:35], v244, s[40:43], s69 offen offset:0 sc1
    buffer_load_dwordx4 v[36:39], v244, s[40:43], s69 offen offset:2048 sc1
    buffer_load_dwordx4 v[40:43], v244, s[40:43], s95 offen offset:0 sc1
    buffer_load_dwordx4 v[44:47], v244, s[40:43], s95 offen offset:2048 sc1
    s_waitcnt vmcnt(0)
Lhc2:
    s_add_u32 s57, s57, 1
    v_cmp_ne_u64 vcc, s[86:87], v[34:35]
    v_cmp_ne_u64 s[88:89], s[86:87], v[38:39]
    s_or_b64 vcc, vcc, s[88:89]
    v_cmp_ne_u64 s[88:89], s[86:87], v[42:43]
    s_or_b64 vcc, vcc, s[88:89]
    v_cmp_ne_u64 s[88:89], s[86:87], v[46:47]
    s_or_b64 vcc, vcc, s[88:89]
    s_cmp_ge_u32 s57, 100000
    s_cbranch_scc1 Lhc4
    s_cbranch_vccnz Lhc1
Lhc4:
    v_add_f32 v32, v32, v36
    v_add_f32 v33, v33, v37
    v_add_f32 v40, v40, v44
    v_add_f32 v41, v41, v45
    s_and_b32 s57, s46, 1
    s_lshl_b32 s57, s57, 9
    s_add_u32 s57, s57, 162816
    v_lshl_add_u32 v3, v1, 3, s57
    v_add_f32 v32, v32, v40
    v_add_f32 v33, v33, v41
    v_cmp_gt_u32 vcc, 163712, v3
    s_and_saveexec_b64 s[88:89], vcc
    ds_write_b64 v3, v[32:33]
    s_mov_b64 exec, -1
Lhc3:
    s_waitcnt lgkmcnt(0)
    s_barrier
    s_waitcnt lgkmcnt(0)
    s_barrier
    s_branch Lp2
Lcomp:
    s_load_dwordx2 s[20:21], s[0:1], 32
    s_mov_b32 s22, 524288
    s_mov_b32 s23, 0x20000
    s_load_dwordx2 s[28:29], s[0:1], 64
    s_mov_b32 s30, 1409024
    s_mov_b32 s31, 0x20000
    v_and_b32 v3, 15, v1
    v_lshrrev_b32 v4, 1, v3
    v_lshrrev_b32 v5, 4, v1
    v_xor_b32 v4, v4, v5
    v_lshlrev_b32 v3, 7, v3
    s_and_b32 s57, s46, 1
    s_lshl_b32 s57, s57, 13
    v_add_u32 v3, s57, v3
    v_lshl_add_u32 v68, v4, 4, v3
    v_xor_b32 v69, 64, v68
    v_lshrrev_b32 v3, 4, v1
    v_bfe_u32 v4, v1, 2, 2
    v_lshl_add_u32 v3, v3, 3, v4
    v_mul_u32_u24 v3, 192, v3
    v_bfe_u32 v4, v1, 4, 1
    v_lshl_add_u32 v3, v4, 5, v3
    v_and_b32 v4, 3, v1
    v_lshl_add_u32 v70, v4, 3, v3
    s_lshl_b32 s58, s46, 4
    s_and_b32 s58, s58, 32
    v_xor_b32 v70, s58, v70
    v_xor_b32 v71, 32, v70
    s_lshl_b32 s59, s58, 1
    v_add_u32 v70, s59, v70
    s_lshl_b32 s59, s58, 2
    v_add_u32 v71, s59, v71
    v_lshrrev_b32 v3, 4, v1
    v_bfe_u32 v4, v1, 2, 2
    v_lshl_add_u32 v3, v3, 3, v4
    v_mul_u32_u24 v3, 64, v3
    v_bfe_u32 v4, v1, 4, 1
    v_lshl_add_u32 v3, v4, 5, v3
    v_and_b32 v4, 3, v1
    v_lshl_add_u32 v72, v4, 3, v3
    v_xor_b32 v72, s58, v72
    v_and_b32 v3, 15, v1
    v_cmp_eq_u32 vcc, 0, v3
    v_mov_b32 v4, 0x3f803f80
    s_nop 0
    v_cndmask_b32 v92, 0, v4, vcc
    v_mov_b32 v93, v92
    v_mov_b32 v94, v92
    v_mov_b32 v95, v92
    s_bfe_u32 s59, s46, 0x10001
    s_mul_i32 s59, s59, 448
    s_add_u32 s59, s59, 162816
    s_and_b32 s58, s46, 1
    s_lshl_b32 s58, s58, 6
    s_add_u32 s58, s59, s58
    v_and_b32 v212, 48, v1
    v_add_u32 v212, s59, v212
    v_add_u32 v213, s58, v1
    s_lshl_b32 s57, s44, 2
    s_and_b32 s58, s46, 1
    s_lshl_b32 s58, s58, 1
    s_add_u32 s57, s57, s58
    s_mul_i32 s57, s57, 88
    s_mul_i32 s58, s45, 6
    s_min_u32 s58, s58, 80
    s_bfe_u32 s59, s46, 0x10001
    s_mul_i32 s59, s59, 3
    s_add_u32 s58, s58, s59
    s_and_b32 s59, s46, 2
    s_add_u32 s60, s58, 0
    s_lshr_b32 s94, s60, 2
    s_add_u32 s94, s94, s57
    s_and_b32 s60, s60, 3
    s_mul_i32 s60, s60, 22
    s_add_u32 s94, s94, s60
    s_lshl_b32 s94, s94, 10
    s_add_u32 s94, s94, 135168
    s_mul_i32 s60, s45, 6
    s_sub_u32 s60, s60, 0
    s_cmp_lt_i32 s58, s60
    s_cselect_b32 s94, 8460288, s94
    s_add_u32 s60, s58, 1
    s_lshr_b32 s95, s60, 2
    s_add_u32 s95, s95, s57
    s_and_b32 s60, s60, 3
    s_mul_i32 s60, s60, 22
    s_add_u32 s95, s95, s60
    s_lshl_b32 s95, s95, 10
    s_add_u32 s95, s95, 135168
    s_mul_i32 s60, s45, 6
    s_sub_u32 s60, s60, 1
    s_cmp_lt_i32 s58, s60
    s_cselect_b32 s95, 8460288, s95
    s_add_u32 s60, s58, 2
    s_lshr_b32 s96, s60, 2
    s_add_u32 s96, s96, s57
    s_and_b32 s60, s60, 3
    s_mul_i32 s60, s60, 22
    s_add_u32 s96, s96, s60
    s_lshl_b32 s96, s96, 10
    s_add_u32 s96, s96, 135168
    s_mul_i32 s60, s45, 6
    s_sub_u32 s60, s60, 2
    s_cmp_lt_i32 s58, s60
    s_cselect_b32 s96, 8460288, s96
    v_bfe_u32 v3, v1, 4, 1
    v_lshlrev_b32 v3, 9, v3
    v_and_b32 v4, 15, v1
    v_lshl_add_u32 v3, v4, 4, v3
    v_lshl_add_u32 v73, v2, 8, v3
    v_add_u32 v214, 90112, v73
    s_and_b32 s57, s46, 1
    s_lshl_b32 s58, s57, 10
    s_add_u32 s58, s58, 160768
    v_lshl_add_u32 v74, v4, 4, s58
    s_lshl_b32 s57, s57, 12
    s_lshl_b32 s59, s59, 9
    s_add_u32 s57, s57, s59
    s_add_u32 s57, s57, 135168
    v_lshl_add_u32 v3, v2, 3, v3
    v_add_u32 v75, s57, v3
    v_lshrrev_b32 v3, 3, v1
    v_lshlrev_b32 v3, 10, v3
    v_and_b32 v4, 7, v1
    v_bfe_u32 v5, v1, 4, 1
    v_lshlrev_b32 v5, 2, v5
    v_xor_b32 v4, v4, v5
    v_lshl_add_u32 v243, v4, 4, v3
    v_add_u32 v255, 7168, v243
    s_lshl_b32 s67, s47, 14
    s_lshl_b32 s58, s62, 7
    s_add_u32 s67, s67, s58
    s_lshl_b32 s68, s47, 11
    s_mul_i32 s66, s61, 176
    s_mul_i32 s57, s47, 22
    s_add_u32 s66, s66, s57
    s_lshl_b32 s66, s66, 10
    s_add_u32 s66, s66, 135168
    s_lshl_b32 s57, s61, 3
    s_add_u32 s57, s57, s47
    s_lshl_b32 s57, s57, 13
    s_add_u32 s71, s57, 5902336
    s_add_u32 s72, s71, 4096
    s_add_u32 s80, s71, 32768
    s_add_u32 s81, s71, 36864
    s_lshr_b32 s69, s61, 1
    s_lshl_b32 s69, s69, 11
    s_add_u32 s69, s69, 7999488
    s_lshl_b32 s73, s44, 4
    s_add_u32 s73, s73, s45
    s_lshl_b32 s73, s73, 7
    s_add_u32 s73, s73, 7999488
    v_bfe_u32 v3, v1, 2, 2
    v_lshl_add_u32 v3, v2, 2, v3
    v_lshlrev_b32 v3, 7, v3
    v_bfe_u32 v4, v1, 4, 1
    v_lshl_add_u32 v3, v4, 5, v3
    v_and_b32 v4, 3, v1
    v_lshl_add_u32 v3, v4, 3, v3
    v_bfe_u32 v4, v1, 3, 1
    v_lshl_add_u32 v3, v4, 6, v3
    v_add_u32 v248, s68, v3
    v_xor_b32 v249, 64, v248
    v_add_u32 v250, 135168, v248
    v_add_u32 v251, 135168, v249
    s_mul_i32 s57, s47, 2112
    v_add_u32 v238, s57, v244
    v_add_u32 v252, 34048, v238
    v_add_u32 v239, 102144, v238
    v_mov_b64 v[76:77], 0
    v_mov_b64 v[78:79], 0
    v_mov_b64 v[80:81], 0
    v_mov_b64 v[82:83], 0
    v_mov_b64 v[84:85], 0
    v_mov_b64 v[86:87], 0
    v_mov_b64 v[88:89], 0
    v_mov_b64 v[90:91], 0
    v_mov_b64 v[96:97], 0
    v_mov_b64 v[98:99], 0
    v_mov_b64 v[100:101], 0
    v_mov_b64 v[102:103], 0
    v_mov_b64 v[104:105], 0
    v_mov_b64 v[106:107], 0
    v_mov_b64 v[108:109], 0
    v_mov_b64 v[110:111], 0
    v_mov_b64 v[112:113], 0
    v_mov_b64 v[114:115], 0
    v_mov_b64 v[116:117], 0
    v_mov_b64 v[118:119], 0
    v_mov_b64 v[120:121], 0
    v_mov_b64 v[122:123], 0
    v_mov_b64 v[124:125], 0
    v_mov_b64 v[126:127], 0
    v_mov_b64 v[128:129], 0
    v_mov_b64 v[130:131], 0
    v_mov_b64 v[132:133], 0
    v_mov_b64 v[134:135], 0
    v_mov_b64 v[136:137], 0
    v_mov_b64 v[138:139], 0
    v_mov_b64 v[140:141], 0
    v_mov_b64 v[142:143], 0
    v_mov_b64 v[160:161], 0
    v_mov_b64 v[162:163], 0
    v_mov_b64 v[164:165], 0
    v_mov_b64 v[166:167], 0
    v_mov_b64 v[168:169], 0
    v_mov_b64 v[170:171], 0
    v_mov_b64 v[172:173], 0
    v_mov_b64 v[174:175], 0
    v_mov_b64 v[176:177], 0
    v_mov_b64 v[178:179], 0
    v_mov_b64 v[180:181], 0
    v_mov_b64 v[182:183], 0
    v_mov_b64 v[184:185], 0
    v_mov_b64 v[186:187], 0
    v_mov_b64 v[188:189], 0
    v_mov_b64 v[190:191], 0
    v_mov_b64 v[192:193], 0
    v_mov_b64 v[194:195], 0
    v_mov_b64 v[196:197], 0
    v_mov_b64 v[198:199], 0
    v_mov_b64 v[200:201], 0
    v_mov_b64 v[202:203], 0
    v_mov_b64 v[204:205], 0
    v_mov_b64 v[206:207], 0
    s_waitcnt vmcnt(0)
    v_mov_b32 v3, 0x3f803f80
    v_dot2_f32_bf16 v152, v144, v3, 0
    v_dot2_f32_bf16 v153, v144, v144, 0
    v_dot2_f32_bf16 v154, v148, v3, 0
    v_dot2_f32_bf16 v155, v148, v148, 0
    v_dot2_f32_bf16 v152, v145, v3, v152
    v_dot2_f32_bf16 v153, v145, v145, v153
    v_dot2_f32_bf16 v154, v149, v3, v154
    v_dot2_f32_bf16 v155, v149, v149, v155
    v_dot2_f32_bf16 v152, v146, v3, v152
    v_dot2_f32_bf16 v153, v146, v146, v153
    v_dot2_f32_bf16 v154, v150, v3, v154
    v_dot2_f32_bf16 v155, v150, v150, v155
    v_dot2_f32_bf16 v152, v147, v3, v152
    v_dot2_f32_bf16 v153, v147, v147, v153
    v_dot2_f32_bf16 v154, v151, v3, v154
    v_dot2_f32_bf16 v155, v151, v151, v155
    s_nop 2
    v_add_f32_dpp v152, v152, v152 row_shr:1 row_mask:0xf bank_mask:0xf bound_ctrl:0
    v_add_f32_dpp v153, v153, v153 row_shr:1 row_mask:0xf bank_mask:0xf bound_ctrl:0
    v_add_f32_dpp v154, v154, v154 row_shr:1 row_mask:0xf bank_mask:0xf bound_ctrl:0
    v_add_f32_dpp v155, v155, v155 row_shr:1 row_mask:0xf bank_mask:0xf bound_ctrl:0
    v_add_f32_dpp v152, v152, v152 row_shr:2 row_mask:0xf bank_mask:0xf bound_ctrl:0
    v_add_f32_dpp v153, v153, v153 row_shr:2 row_mask:0xf bank_mask:0xf bound_ctrl:0
    v_add_f32_dpp v154, v154, v154 row_shr:2 row_mask:0xf bank_mask:0xf bound_ctrl:0
    v_add_f32_dpp v155, v155, v155 row_shr:2 row_mask:0xf bank_mask:0xf bound_ctrl:0
    v_add_f32_dpp v152, v152, v152 row_shr:4 row_mask:0xf bank_mask:0xf bound_ctrl:0
    v_add_f32_dpp v153, v153, v153 row_shr:4 row_mask:0xf bank_mask:0xf bound_ctrl:0
    v_add_f32_dpp v154, v154, v154 row_shr:4 row_mask:0xf bank_mask:0xf bound_ctrl:0
    v_add_f32_dpp v155, v155, v155 row_shr:4 row_mask:0xf bank_mask:0xf bound_ctrl:0
    v_add_f32_dpp v152, v152, v152 row_shr:8 row_mask:0xf bank_mask:0xf bound_ctrl:0
    v_add_f32_dpp v153, v153, v153 row_shr:8 row_mask:0xf bank_mask:0xf bound_ctrl:0
    v_add_f32_dpp v154, v154, v154 row_shr:8 row_mask:0xf bank_mask:0xf bound_ctrl:0
    v_add_f32_dpp v155, v155, v155 row_shr:8 row_mask:0xf bank_mask:0xf bound_ctrl:0
    v_add_f32_dpp v152, v152, v152 row_bcast:15 row_mask:0xa bank_mask:0xf
    v_add_f32_dpp v153, v153, v153 row_bcast:15 row_mask:0xa bank_mask:0xf
    v_add_f32_dpp v154, v154, v154 row_bcast:15 row_mask:0xa bank_mask:0xf
    v_add_f32_dpp v155, v155, v155 row_bcast:15 row_mask:0xa bank_mask:0xf
    v_add_f32_dpp v152, v152, v152 row_bcast:31 row_mask:0xc bank_mask:0xf
    v_add_f32_dpp v153, v153, v153 row_bcast:31 row_mask:0xc bank_mask:0xf
    v_add_f32_dpp v154, v154, v154 row_bcast:31 row_mask:0xc bank_mask:0xf
    v_add_f32_dpp v155, v155, v155 row_bcast:31 row_mask:0xc bank_mask:0xf
    v_mul_f32 v144, 0x3b000000, v152
    v_mul_f32 v145, 0x3b000000, v153
    v_fma_f32 v145, -v144, v144, v145
    v_max_f32 v145, 0, v145
    v_add_f32 v145, 0x3727c5ac, v145
    v_rsq_f32 v145, v145
    v_mul_f32 v148, 0x3b000000, v154
    v_mul_f32 v149, 0x3b000000, v155
    v_fma_f32 v149, -v148, v148, v149
    v_max_f32 v149, 0, v149
    v_add_f32 v149, 0x3727c5ac, v149
    v_rsq_f32 v149, v149
    s_lshl_b32 s57, s47, 4
    s_add_u32 s57, s57, 162816
    v_mov_b32 v3, s57
    s_mov_b32 exec_lo, 0
    s_brev_b32 exec_hi, 1
    ds_write_b64 v3, v[144:145]
    ds_write_b64 v3, v[148:149] offset:8
    s_mov_b64 exec, -1
    s_cmp_lg_u32 s45, 14
    s_cbranch_scc1 Lnr2
    v_mov_b32 v3, 0x3f803f80
    v_dot2_f32_bf16 v224, v216, v3, 0
    v_dot2_f32_bf16 v225, v216, v216, 0
    v_dot2_f32_bf16 v226, v220, v3, 0
    v_dot2_f32_bf16 v227, v220, v220, 0
    v_dot2_f32_bf16 v224, v217, v3, v224
    v_dot2_f32_bf16 v225, v217, v217, v225
    v_dot2_f32_bf16 v226, v221, v3, v226
    v_dot2_f32_bf16 v227, v221, v221, v227
    v_dot2_f32_bf16 v224, v218, v3, v224
    v_dot2_f32_bf16 v225, v218, v218, v225
    v_dot2_f32_bf16 v226, v222, v3, v226
    v_dot2_f32_bf16 v227, v222, v222, v227
    v_dot2_f32_bf16 v224, v219, v3, v224
    v_dot2_f32_bf16 v225, v219, v219, v225
    v_dot2_f32_bf16 v226, v223, v3, v226
    v_dot2_f32_bf16 v227, v223, v223, v227
    s_nop 2
    v_add_f32_dpp v224, v224, v224 row_shr:1 row_mask:0xf bank_mask:0xf bound_ctrl:0
    v_add_f32_dpp v225, v225, v225 row_shr:1 row_mask:0xf bank_mask:0xf bound_ctrl:0
    v_add_f32_dpp v226, v226, v226 row_shr:1 row_mask:0xf bank_mask:0xf bound_ctrl:0
    v_add_f32_dpp v227, v227, v227 row_shr:1 row_mask:0xf bank_mask:0xf bound_ctrl:0
    v_add_f32_dpp v224, v224, v224 row_shr:2 row_mask:0xf bank_mask:0xf bound_ctrl:0
    v_add_f32_dpp v225, v225, v225 row_shr:2 row_mask:0xf bank_mask:0xf bound_ctrl:0
    v_add_f32_dpp v226, v226, v226 row_shr:2 row_mask:0xf bank_mask:0xf bound_ctrl:0
    v_add_f32_dpp v227, v227, v227 row_shr:2 row_mask:0xf bank_mask:0xf bound_ctrl:0
    v_add_f32_dpp v224, v224, v224 row_shr:4 row_mask:0xf bank_mask:0xf bound_ctrl:0
    v_add_f32_dpp v225, v225, v225 row_shr:4 row_mask:0xf bank_mask:0xf bound_ctrl:0
    v_add_f32_dpp v226, v226, v226 row_shr:4 row_mask:0xf bank_mask:0xf bound_ctrl:0
    v_add_f32_dpp v227, v227, v227 row_shr:4 row_mask:0xf bank_mask:0xf bound_ctrl:0
    v_add_f32_dpp v224, v224, v224 row_shr:8 row_mask:0xf bank_mask:0xf bound_ctrl:0
    v_add_f32_dpp v225, v225, v225 row_shr:8 row_mask:0xf bank_mask:0xf bound_ctrl:0
    v_add_f32_dpp v226, v226, v226 row_shr:8 row_mask:0xf bank_mask:0xf bound_ctrl:0
    v_add_f32_dpp v227, v227, v227 row_shr:8 row_mask:0xf bank_mask:0xf bound_ctrl:0
    v_add_f32_dpp v224, v224, v224 row_bcast:15 row_mask:0xa bank_mask:0xf
    v_add_f32_dpp v225, v225, v225 row_bcast:15 row_mask:0xa bank_mask:0xf
    v_add_f32_dpp v226, v226, v226 row_bcast:15 row_mask:0xa bank_mask:0xf
    v_add_f32_dpp v227, v227, v227 row_bcast:15 row_mask:0xa bank_mask:0xf
    v_add_f32_dpp v224, v224, v224 row_bcast:31 row_mask:0xc bank_mask:0xf
    v_add_f32_dpp v225, v225, v225 row_bcast:31 row_mask:0xc bank_mask:0xf
    v_add_f32_dpp v226, v226, v226 row_bcast:31 row_mask:0xc bank_mask:0xf
    v_add_f32_dpp v227, v227, v227 row_bcast:31 row_mask:0xc bank_mask:0xf
    v_mul_f32 v216, 0x3b000000, v224
    v_mul_f32 v217, 0x3b000000, v225
    v_fma_f32 v217, -v216, v216, v217
    v_max_f32 v217, 0, v217
    v_add_f32 v217, 0x3727c5ac, v217
    v_rsq_f32 v217, v217
    v_mul_f32 v220, 0x3b000000, v226
    v_mul_f32 v221, 0x3b000000, v227
    v_fma_f32 v221, -v220, v220, v221
    v_max_f32 v221, 0, v221
    v_add_f32 v221, 0x3727c5ac, v221
    v_rsq_f32 v221, v221
    s_lshl_b32 s57, s47, 4
    s_add_u32 s57, s57, 162880
    v_mov_b32 v3, s57
    s_mov_b32 exec_lo, 0
    s_brev_b32 exec_hi, 1
    ds_write_b64 v3, v[216:217]
    ds_write_b64 v3, v[220:221] offset:8
    s_mov_b64 exec, -1
Lnr2:
    s_nop 1
    v_mov_b64 v[144:145], 0
    v_mov_b64 v[146:147], 0
    v_mov_b64 v[148:149], 0
    v_mov_b64 v[150:151], 0
    v_mov_b64 v[152:153], 0
    v_mov_b64 v[154:155], 0
    v_mov_b64 v[156:157], 0
    v_mov_b64 v[158:159], 0
    s_mov_b32 s55, 0
    s_mov_b32 s3, 0
    s_mov_b32 s97, 4294877184
    s_setprio 2
    s_waitcnt lgkmcnt(0)
    s_barrier
    ds_read_b128 v[8:11], v68 offset:0
    ds_read_b128 v[12:15], v68 offset:2048
    ds_read_b128 v[16:19], v68 offset:4096
    ds_read_b128 v[20:23], v68 offset:6144
    ds_read_b64_tr_b16 v[40:41], v72 offset:40960
    ds_read_b64_tr_b16 v[42:43], v72 offset:41216
    ds_read_b64_tr_b16 v[44:45], v70 offset:16384
    ds_read_b64_tr_b16 v[46:47], v70 offset:17152
    ds_read_b64_tr_b16 v[48:49], v71 offset:16384
    ds_read_b64_tr_b16 v[50:51], v71 offset:17152
    ds_read_b64_tr_b16 v[52:53], v70 offset:16448
    ds_read_b64_tr_b16 v[54:55], v70 offset:17216
    ds_read_b64_tr_b16 v[56:57], v70 offset:28672
    ds_read_b64_tr_b16 v[58:59], v70 offset:29440
    ds_read_b64_tr_b16 v[60:61], v71 offset:28672
    ds_read_b64_tr_b16 v[62:63], v71 offset:29440
    ds_read_b64_tr_b16 v[64:65], v70 offset:28736
    ds_read_b64_tr_b16 v[66:67], v70 offset:29504
    s_and_b32 s57, s44, 6
    s_cmp_lg_u32 s57, 0
    s_waitcnt lgkmcnt(0)
    s_cbranch_scc1 Lc_2
    s_bitcmp1_b32 s46, 0
    s_cbranch_scc1 Lc_1
    .p2align 3
Lc_0:
    s_waitcnt lgkmcnt(10)
    v_mfma_f32_16x16x32_bf16 v[96:99], v[40:43], v[8:11], v[96:99]
    ds_read_b128 v[24:27], v69 offset:0
    v_mfma_f32_16x16x32_bf16 v[124:127], v[40:43], v[12:15], v[124:127]
    ds_read_b128 v[28:31], v69 offset:2048
    v_mfma_f32_16x16x32_bf16 v[152:155], v[40:43], v[16:19], v[152:155]
    ds_read_b128 v[32:35], v69 offset:4096
    v_mfma_f32_16x16x32_bf16 v[180:183], v[40:43], v[20:23], v[180:183]
    ds_read_b128 v[36:39], v69 offset:6144
    v_mfma_f32_16x16x32_bf16 v[76:79], v[40:43], v[92:95], v[76:79]
    v_mfma_f32_16x16x32_bf16 v[100:103], v[44:47], v[8:11], v[100:103]
    ds_read_b64_tr_b16 v[40:41], v72 offset:43008
    v_mfma_f32_16x16x32_bf16 v[128:131], v[44:47], v[12:15], v[128:131]
    ds_read_b64_tr_b16 v[42:43], v72 offset:43264
    v_mfma_f32_16x16x32_bf16 v[156:159], v[44:47], v[16:19], v[156:159]
    v_mfma_f32_16x16x32_bf16 v[184:187], v[44:47], v[20:23], v[184:187]
    s_waitcnt lgkmcnt(12)
    v_mfma_f32_16x16x32_bf16 v[104:107], v[48:51], v[8:11], v[104:107]
    ds_read_b64_tr_b16 v[44:45], v70 offset:22528
    v_mfma_f32_16x16x32_bf16 v[132:135], v[48:51], v[12:15], v[132:135]
    ds_read_b64_tr_b16 v[46:47], v70 offset:23296
    v_mfma_f32_16x16x32_bf16 v[160:163], v[48:51], v[16:19], v[160:163]
    v_mfma_f32_16x16x32_bf16 v[188:191], v[48:51], v[20:23], v[188:191]
    v_mfma_f32_16x16x32_bf16 v[80:83], v[48:51], v[92:95], v[80:83]
    v_mfma_f32_16x16x32_bf16 v[108:111], v[52:55], v[8:11], v[108:111]
    ds_read_b64_tr_b16 v[48:49], v71 offset:22528
    v_mfma_f32_16x16x32_bf16 v[136:139], v[52:55], v[12:15], v[136:139]
    ds_read_b64_tr_b16 v[50:51], v71 offset:23296
    v_mfma_f32_16x16x32_bf16 v[164:167], v[52:55], v[16:19], v[164:167]
    v_mfma_f32_16x16x32_bf16 v[192:195], v[52:55], v[20:23], v[192:195]
    s_waitcnt lgkmcnt(12)
    v_mfma_f32_16x16x32_bf16 v[112:115], v[56:59], v[8:11], v[112:115]
    ds_read_b64_tr_b16 v[52:53], v70 offset:22592
    v_mfma_f32_16x16x32_bf16 v[140:143], v[56:59], v[12:15], v[140:143]
    ds_read_b64_tr_b16 v[54:55], v70 offset:23360
    v_mfma_f32_16x16x32_bf16 v[168:171], v[56:59], v[16:19], v[168:171]
    s_add_u32 s3, s3, 1
    v_mfma_f32_16x16x32_bf16 v[196:199], v[56:59], v[20:23], v[196:199]
    s_cmp_eq_u32 s3, 3
    v_mfma_f32_16x16x32_bf16 v[84:87], v[56:59], v[92:95], v[84:87]
    s_cselect_b32 s56, s97, 45056
    v_mfma_f32_16x16x32_bf16 v[116:119], v[60:63], v[8:11], v[116:119]
    s_cselect_b32 s3, 0, s3
    v_mfma_f32_16x16x32_bf16 v[144:147], v[60:63], v[12:15], v[144:147]
    s_add_u32 s55, s55, 1
    v_mfma_f32_16x16x32_bf16 v[172:175], v[60:63], v[16:19], v[172:175]
    ds_read_b64_tr_b16 v[56:57], v70 offset:34816
    v_mfma_f32_16x16x32_bf16 v[200:203], v[60:63], v[20:23], v[200:203]
    ds_read_b64_tr_b16 v[58:59], v70 offset:35584
    s_waitcnt lgkmcnt(14)
    v_mfma_f32_16x16x32_bf16 v[120:123], v[64:67], v[8:11], v[120:123]
    ds_read_b64_tr_b16 v[60:61], v71 offset:34816
    v_mfma_f32_16x16x32_bf16 v[148:151], v[64:67], v[12:15], v[148:151]
    ds_read_b64_tr_b16 v[62:63], v71 offset:35584
    v_mfma_f32_16x16x32_bf16 v[176:179], v[64:67], v[16:19], v[176:179]
    v_mfma_f32_16x16x32_bf16 v[204:207], v[64:67], v[20:23], v[204:207]
    v_mfma_f32_16x16x32_bf16 v[88:91], v[64:67], v[92:95], v[88:91]
    s_waitcnt lgkmcnt(8)
    v_mfma_f32_16x16x32_bf16 v[96:99], v[40:43], v[24:27], v[96:99]
    ds_read_b64_tr_b16 v[64:65], v70 offset:34880
    v_mfma_f32_16x16x32_bf16 v[124:127], v[40:43], v[28:31], v[124:127]
    ds_read_b64_tr_b16 v[66:67], v70 offset:35648
    v_mfma_f32_16x16x32_bf16 v[152:155], v[40:43], v[32:35], v[152:155]
    v_add_u32 v68, s56, v68
    v_mfma_f32_16x16x32_bf16 v[180:183], v[40:43], v[36:39], v[180:183]
    v_add_u32 v69, s56, v69
    v_mfma_f32_16x16x32_bf16 v[76:79], v[40:43], v[92:95], v[76:79]
    v_add_u32 v70, s56, v70
    v_mfma_f32_16x16x32_bf16 v[100:103], v[44:47], v[24:27], v[100:103]
    v_add_u32 v71, s56, v71
    v_mfma_f32_16x16x32_bf16 v[128:131], v[44:47], v[28:31], v[128:131]
    v_add_u32 v72, s56, v72
    v_mfma_f32_16x16x32_bf16 v[156:159], v[44:47], v[32:35], v[156:159]
    v_mfma_f32_16x16x32_bf16 v[184:187], v[44:47], v[36:39], v[184:187]
    s_waitcnt lgkmcnt(0)
    s_barrier
    v_mfma_f32_16x16x32_bf16 v[104:107], v[48:51], v[24:27], v[104:107]
    ds_read_b128 v[8:11], v68 offset:0
    v_mfma_f32_16x16x32_bf16 v[132:135], v[48:51], v[28:31], v[132:135]
    ds_read_b128 v[12:15], v68 offset:2048
    v_mfma_f32_16x16x32_bf16 v[160:163], v[48:51], v[32:35], v[160:163]
    ds_read_b128 v[16:19], v68 offset:4096
    v_mfma_f32_16x16x32_bf16 v[188:191], v[48:51], v[36:39], v[188:191]
    ds_read_b128 v[20:23], v68 offset:6144
    v_mfma_f32_16x16x32_bf16 v[80:83], v[48:51], v[92:95], v[80:83]
    ds_read_b64_tr_b16 v[40:41], v72 offset:40960
    v_mfma_f32_16x16x32_bf16 v[108:111], v[52:55], v[24:27], v[108:111]
    ds_read_b64_tr_b16 v[42:43], v72 offset:41216
    v_mfma_f32_16x16x32_bf16 v[136:139], v[52:55], v[28:31], v[136:139]
    ds_read_b64_tr_b16 v[44:45], v70 offset:16384
    v_mfma_f32_16x16x32_bf16 v[164:167], v[52:55], v[32:35], v[164:167]
    ds_read_b64_tr_b16 v[46:47], v70 offset:17152
    v_mfma_f32_16x16x32_bf16 v[192:195], v[52:55], v[36:39], v[192:195]
    ds_read_b64_tr_b16 v[48:49], v71 offset:16384
    v_mfma_f32_16x16x32_bf16 v[112:115], v[56:59], v[24:27], v[112:115]
    ds_read_b64_tr_b16 v[50:51], v71 offset:17152
    v_mfma_f32_16x16x32_bf16 v[140:143], v[56:59], v[28:31], v[140:143]
    ds_read_b64_tr_b16 v[52:53], v70 offset:16448
    v_mfma_f32_16x16x32_bf16 v[168:171], v[56:59], v[32:35], v[168:171]
    ds_read_b64_tr_b16 v[54:55], v70 offset:17216
    v_mfma_f32_16x16x32_bf16 v[196:199], v[56:59], v[36:39], v[196:199]
    v_mfma_f32_16x16x32_bf16 v[84:87], v[56:59], v[92:95], v[84:87]
    v_mfma_f32_16x16x32_bf16 v[116:119], v[60:63], v[24:27], v[116:119]
    ds_read_b64_tr_b16 v[56:57], v70 offset:28672
    v_mfma_f32_16x16x32_bf16 v[144:147], v[60:63], v[28:31], v[144:147]
    ds_read_b64_tr_b16 v[58:59], v70 offset:29440
    v_mfma_f32_16x16x32_bf16 v[172:175], v[60:63], v[32:35], v[172:175]
    v_mfma_f32_16x16x32_bf16 v[200:203], v[60:63], v[36:39], v[200:203]
    v_mfma_f32_16x16x32_bf16 v[120:123], v[64:67], v[24:27], v[120:123]
    ds_read_b64_tr_b16 v[60:61], v71 offset:28672
    v_mfma_f32_16x16x32_bf16 v[148:151], v[64:67], v[28:31], v[148:151]
    ds_read_b64_tr_b16 v[62:63], v71 offset:29440
    v_mfma_f32_16x16x32_bf16 v[176:179], v[64:67], v[32:35], v[176:179]
    v_mfma_f32_16x16x32_bf16 v[204:207], v[64:67], v[36:39], v[204:207]
    v_mfma_f32_16x16x32_bf16 v[88:91], v[64:67], v[92:95], v[88:91]
    ds_read_b64_tr_b16 v[64:65], v70 offset:28736
    ds_read_b64_tr_b16 v[66:67], v70 offset:29504
    s_cmp_lt_u32 s55, 2
    s_cbranch_scc1 Lc_0
    s_nop 2
    s_mov_b32 exec_lo, 0x00010001
    s_mov_b32 exec_hi, 0x00010001
    ds_write_b128 v213, v[76:79] offset:0
    ds_write_b128 v213, v[80:83] offset:128
    ds_write_b128 v213, v[84:87] offset:256
    ds_write_b128 v213, v[88:91] offset:384
    s_mov_b64 exec, -1
    s_branch Lc_2
    .p2align 3
Lc_1:
    s_waitcnt lgkmcnt(10)
    v_mfma_f32_16x16x32_bf16 v[96:99], v[40:43], v[8:11], v[96:99]
    ds_read_b128 v[24:27], v69 offset:0
    v_mfma_f32_16x16x32_bf16 v[124:127], v[40:43], v[12:15], v[124:127]
    ds_read_b128 v[28:31], v69 offset:2048
    v_mfma_f32_16x16x32_bf16 v[152:155], v[40:43], v[16:19], v[152:155]
    ds_read_b128 v[32:35], v69 offset:4096
    v_mfma_f32_16x16x32_bf16 v[180:183], v[40:43], v[20:23], v[180:183]
    ds_read_b128 v[36:39], v69 offset:6144
    v_mfma_f32_16x16x32_bf16 v[100:103], v[44:47], v[8:11], v[100:103]
    ds_read_b64_tr_b16 v[40:41], v72 offset:43008
    v_mfma_f32_16x16x32_bf16 v[128:131], v[44:47], v[12:15], v[128:131]
    ds_read_b64_tr_b16 v[42:43], v72 offset:43264
    v_mfma_f32_16x16x32_bf16 v[156:159], v[44:47], v[16:19], v[156:159]
    v_mfma_f32_16x16x32_bf16 v[184:187], v[44:47], v[20:23], v[184:187]
    v_mfma_f32_16x16x32_bf16 v[76:79], v[44:47], v[92:95], v[76:79]
    s_waitcnt lgkmcnt(12)
    v_mfma_f32_16x16x32_bf16 v[104:107], v[48:51], v[8:11], v[104:107]
    ds_read_b64_tr_b16 v[44:45], v70 offset:22528
    v_mfma_f32_16x16x32_bf16 v[132:135], v[48:51], v[12:15], v[132:135]
    ds_read_b64_tr_b16 v[46:47], v70 offset:23296
    v_mfma_f32_16x16x32_bf16 v[160:163], v[48:51], v[16:19], v[160:163]
    v_mfma_f32_16x16x32_bf16 v[188:191], v[48:51], v[20:23], v[188:191]
    v_mfma_f32_16x16x32_bf16 v[108:111], v[52:55], v[8:11], v[108:111]
    ds_read_b64_tr_b16 v[48:49], v71 offset:22528
    v_mfma_f32_16x16x32_bf16 v[136:139], v[52:55], v[12:15], v[136:139]
    ds_read_b64_tr_b16 v[50:51], v71 offset:23296
    v_mfma_f32_16x16x32_bf16 v[164:167], v[52:55], v[16:19], v[164:167]
    v_mfma_f32_16x16x32_bf16 v[192:195], v[52:55], v[20:23], v[192:195]
    v_mfma_f32_16x16x32_bf16 v[80:83], v[52:55], v[92:95], v[80:83]
    s_waitcnt lgkmcnt(12)
    v_mfma_f32_16x16x32_bf16 v[112:115], v[56:59], v[8:11], v[112:115]
    ds_read_b64_tr_b16 v[52:53], v70 offset:22592
    v_mfma_f32_16x16x32_bf16 v[140:143], v[56:59], v[12:15], v[140:143]
    ds_read_b64_tr_b16 v[54:55], v70 offset:23360
    v_mfma_f32_16x16x32_bf16 v[168:171], v[56:59], v[16:19], v[168:171]
    s_add_u32 s3, s3, 1
    v_mfma_f32_16x16x32_bf16 v[196:199], v[56:59], v[20:23], v[196:199]
    s_cmp_eq_u32 s3, 3
    v_mfma_f32_16x16x32_bf16 v[116:119], v[60:63], v[8:11], v[116:119]
    s_cselect_b32 s56, s97, 45056
    v_mfma_f32_16x16x32_bf16 v[144:147], v[60:63], v[12:15], v[144:147]
    s_cselect_b32 s3, 0, s3
    v_mfma_f32_16x16x32_bf16 v[172:175], v[60:63], v[16:19], v[172:175]
    s_add_u32 s55, s55, 1
    v_mfma_f32_16x16x32_bf16 v[200:203], v[60:63], v[20:23], v[200:203]
    ds_read_b64_tr_b16 v[56:57], v70 offset:34816
    v_mfma_f32_16x16x32_bf16 v[84:87], v[60:63], v[92:95], v[84:87]
    ds_read_b64_tr_b16 v[58:59], v70 offset:35584
    s_waitcnt lgkmcnt(14)
    v_mfma_f32_16x16x32_bf16 v[120:123], v[64:67], v[8:11], v[120:123]
    ds_read_b64_tr_b16 v[60:61], v71 offset:34816
    v_mfma_f32_16x16x32_bf16 v[148:151], v[64:67], v[12:15], v[148:151]
    ds_read_b64_tr_b16 v[62:63], v71 offset:35584
    v_mfma_f32_16x16x32_bf16 v[176:179], v[64:67], v[16:19], v[176:179]
    v_mfma_f32_16x16x32_bf16 v[204:207], v[64:67], v[20:23], v[204:207]
    s_waitcnt lgkmcnt(8)
    v_mfma_f32_16x16x32_bf16 v[96:99], v[40:43], v[24:27], v[96:99]
    ds_read_b64_tr_b16 v[64:65], v70 offset:34880
    v_mfma_f32_16x16x32_bf16 v[124:127], v[40:43], v[28:31], v[124:127]
    ds_read_b64_tr_b16 v[66:67], v70 offset:35648
    v_mfma_f32_16x16x32_bf16 v[152:155], v[40:43], v[32:35], v[152:155]
    v_add_u32 v68, s56, v68
    v_mfma_f32_16x16x32_bf16 v[180:183], v[40:43], v[36:39], v[180:183]
    v_add_u32 v69, s56, v69
    v_mfma_f32_16x16x32_bf16 v[100:103], v[44:47], v[24:27], v[100:103]
    v_add_u32 v70, s56, v70
    v_mfma_f32_16x16x32_bf16 v[128:131], v[44:47], v[28:31], v[128:131]
    v_add_u32 v71, s56, v71
    v_mfma_f32_16x16x32_bf16 v[156:159], v[44:47], v[32:35], v[156:159]
    v_add_u32 v72, s56, v72
    v_mfma_f32_16x16x32_bf16 v[184:187], v[44:47], v[36:39], v[184:187]
    v_mfma_f32_16x16x32_bf16 v[76:79], v[44:47], v[92:95], v[76:79]
    s_waitcnt lgkmcnt(0)
    s_barrier
    v_mfma_f32_16x16x32_bf16 v[104:107], v[48:51], v[24:27], v[104:107]
    ds_read_b128 v[8:11], v68 offset:0
    v_mfma_f32_16x16x32_bf16 v[132:135], v[48:51], v[28:31], v[132:135]
    ds_read_b128 v[12:15], v68 offset:2048
    v_mfma_f32_16x16x32_bf16 v[160:163], v[48:51], v[32:35], v[160:163]
    ds_read_b128 v[16:19], v68 offset:4096
    v_mfma_f32_16x16x32_bf16 v[188:191], v[48:51], v[36:39], v[188:191]
    ds_read_b128 v[20:23], v68 offset:6144
    v_mfma_f32_16x16x32_bf16 v[108:111], v[52:55], v[24:27], v[108:111]
    ds_read_b64_tr_b16 v[40:41], v72 offset:40960
    v_mfma_f32_16x16x32_bf16 v[136:139], v[52:55], v[28:31], v[136:139]
    ds_read_b64_tr_b16 v[42:43], v72 offset:41216
    v_mfma_f32_16x16x32_bf16 v[164:167], v[52:55], v[32:35], v[164:167]
    ds_read_b64_tr_b16 v[44:45], v70 offset:16384
    v_mfma_f32_16x16x32_bf16 v[192:195], v[52:55], v[36:39], v[192:195]
    ds_read_b64_tr_b16 v[46:47], v70 offset:17152
    v_mfma_f32_16x16x32_bf16 v[80:83], v[52:55], v[92:95], v[80:83]
    ds_read_b64_tr_b16 v[48:49], v71 offset:16384
    v_mfma_f32_16x16x32_bf16 v[112:115], v[56:59], v[24:27], v[112:115]
    ds_read_b64_tr_b16 v[50:51], v71 offset:17152
    v_mfma_f32_16x16x32_bf16 v[140:143], v[56:59], v[28:31], v[140:143]
    ds_read_b64_tr_b16 v[52:53], v70 offset:16448
    v_mfma_f32_16x16x32_bf16 v[168:171], v[56:59], v[32:35], v[168:171]
    ds_read_b64_tr_b16 v[54:55], v70 offset:17216
    v_mfma_f32_16x16x32_bf16 v[196:199], v[56:59], v[36:39], v[196:199]
    v_mfma_f32_16x16x32_bf16 v[116:119], v[60:63], v[24:27], v[116:119]
    ds_read_b64_tr_b16 v[56:57], v70 offset:28672
    v_mfma_f32_16x16x32_bf16 v[144:147], v[60:63], v[28:31], v[144:147]
    ds_read_b64_tr_b16 v[58:59], v70 offset:29440
    v_mfma_f32_16x16x32_bf16 v[172:175], v[60:63], v[32:35], v[172:175]
    v_mfma_f32_16x16x32_bf16 v[200:203], v[60:63], v[36:39], v[200:203]
    v_mfma_f32_16x16x32_bf16 v[84:87], v[60:63], v[92:95], v[84:87]
    v_mfma_f32_16x16x32_bf16 v[120:123], v[64:67], v[24:27], v[120:123]
    ds_read_b64_tr_b16 v[60:61], v71 offset:28672
    v_mfma_f32_16x16x32_bf16 v[148:151], v[64:67], v[28:31], v[148:151]
    ds_read_b64_tr_b16 v[62:63], v71 offset:29440
    v_mfma_f32_16x16x32_bf16 v[176:179], v[64:67], v[32:35], v[176:179]
    v_mfma_f32_16x16x32_bf16 v[204:207], v[64:67], v[36:39], v[204:207]
    ds_read_b64_tr_b16 v[64:65], v70 offset:28736
    ds_read_b64_tr_b16 v[66:67], v70 offset:29504
    s_cmp_lt_u32 s55, 2
    s_cbranch_scc1 Lc_1
    s_nop 2
    s_mov_b32 exec_lo, 0x00010001
    s_mov_b32 exec_hi, 0x00010001
    ds_write_b128 v213, v[76:79] offset:0
    ds_write_b128 v213, v[80:83] offset:128
    ds_write_b128 v213, v[84:87] offset:256
    s_mov_b64 exec, -1
    .p2align 3
Lc_2:
    s_waitcnt lgkmcnt(10)
    v_mfma_f32_16x16x32_bf16 v[96:99], v[40:43], v[8:11], v[96:99]
    ds_read_b128 v[24:27], v69 offset:0
    v_mfma_f32_16x16x32_bf16 v[124:127], v[40:43], v[12:15], v[124:127]
    ds_read_b128 v[28:31], v69 offset:2048
    v_mfma_f32_16x16x32_bf16 v[152:155], v[40:43], v[16:19], v[152:155]
    ds_read_b128 v[32:35], v69 offset:4096
    v_mfma_f32_16x16x32_bf16 v[180:183], v[40:43], v[20:23], v[180:183]
    ds_read_b128 v[36:39], v69 offset:6144
    v_mfma_f32_16x16x32_bf16 v[100:103], v[44:47], v[8:11], v[100:103]
    ds_read_b64_tr_b16 v[40:41], v72 offset:43008
    v_mfma_f32_16x16x32_bf16 v[128:131], v[44:47], v[12:15], v[128:131]
    ds_read_b64_tr_b16 v[42:43], v72 offset:43264
    v_mfma_f32_16x16x32_bf16 v[156:159], v[44:47], v[16:19], v[156:159]
    v_mfma_f32_16x16x32_bf16 v[184:187], v[44:47], v[20:23], v[184:187]
    s_waitcnt lgkmcnt(12)
    v_mfma_f32_16x16x32_bf16 v[104:107], v[48:51], v[8:11], v[104:107]
    ds_read_b64_tr_b16 v[44:45], v70 offset:22528
    v_mfma_f32_16x16x32_bf16 v[132:135], v[48:51], v[12:15], v[132:135]
    ds_read_b64_tr_b16 v[46:47], v70 offset:23296
    v_mfma_f32_16x16x32_bf16 v[160:163], v[48:51], v[16:19], v[160:163]
    v_mfma_f32_16x16x32_bf16 v[188:191], v[48:51], v[20:23], v[188:191]
    v_mfma_f32_16x16x32_bf16 v[108:111], v[52:55], v[8:11], v[108:111]
    ds_read_b64_tr_b16 v[48:49], v71 offset:22528
    v_mfma_f32_16x16x32_bf16 v[136:139], v[52:55], v[12:15], v[136:139]
    ds_read_b64_tr_b16 v[50:51], v71 offset:23296
    v_mfma_f32_16x16x32_bf16 v[164:167], v[52:55], v[16:19], v[164:167]
    v_mfma_f32_16x16x32_bf16 v[192:195], v[52:55], v[20:23], v[192:195]
    s_waitcnt lgkmcnt(12)
    v_mfma_f32_16x16x32_bf16 v[112:115], v[56:59], v[8:11], v[112:115]
    ds_read_b64_tr_b16 v[52:53], v70 offset:22592
    v_mfma_f32_16x16x32_bf16 v[140:143], v[56:59], v[12:15], v[140:143]
    ds_read_b64_tr_b16 v[54:55], v70 offset:23360
    v_mfma_f32_16x16x32_bf16 v[168:171], v[56:59], v[16:19], v[168:171]
    s_add_u32 s3, s3, 1
    v_mfma_f32_16x16x32_bf16 v[196:199], v[56:59], v[20:23], v[196:199]
    s_cmp_eq_u32 s3, 3
    v_mfma_f32_16x16x32_bf16 v[116:119], v[60:63], v[8:11], v[116:119]
    s_cselect_b32 s56, s97, 45056
    v_mfma_f32_16x16x32_bf16 v[144:147], v[60:63], v[12:15], v[144:147]
    s_cselect_b32 s3, 0, s3
    v_mfma_f32_16x16x32_bf16 v[172:175], v[60:63], v[16:19], v[172:175]
    s_add_u32 s55, s55, 1
    v_mfma_f32_16x16x32_bf16 v[200:203], v[60:63], v[20:23], v[200:203]
    ds_read_b64_tr_b16 v[56:57], v70 offset:34816
    s_waitcnt lgkmcnt(13)
    v_mfma_f32_16x16x32_bf16 v[120:123], v[64:67], v[8:11], v[120:123]
    ds_read_b64_tr_b16 v[58:59], v70 offset:35584
    v_mfma_f32_16x16x32_bf16 v[148:151], v[64:67], v[12:15], v[148:151]
    ds_read_b64_tr_b16 v[60:61], v71 offset:34816
    v_mfma_f32_16x16x32_bf16 v[176:179], v[64:67], v[16:19], v[176:179]
    ds_read_b64_tr_b16 v[62:63], v71 offset:35584
    v_mfma_f32_16x16x32_bf16 v[204:207], v[64:67], v[20:23], v[204:207]
    s_waitcnt lgkmcnt(8)
    v_mfma_f32_16x16x32_bf16 v[96:99], v[40:43], v[24:27], v[96:99]
    ds_read_b64_tr_b16 v[64:65], v70 offset:34880
    v_mfma_f32_16x16x32_bf16 v[124:127], v[40:43], v[28:31], v[124:127]
    ds_read_b64_tr_b16 v[66:67], v70 offset:35648
    v_mfma_f32_16x16x32_bf16 v[152:155], v[40:43], v[32:35], v[152:155]
    v_add_u32 v68, s56, v68
    v_mfma_f32_16x16x32_bf16 v[180:183], v[40:43], v[36:39], v[180:183]
    v_add_u32 v69, s56, v69
    v_mfma_f32_16x16x32_bf16 v[100:103], v[44:47], v[24:27], v[100:103]
    v_add_u32 v70, s56, v70
    v_mfma_f32_16x16x32_bf16 v[128:131], v[44:47], v[28:31], v[128:131]
    v_add_u32 v71, s56, v71
    v_mfma_f32_16x16x32_bf16 v[156:159], v[44:47], v[32:35], v[156:159]
    v_add_u32 v72, s56, v72
    v_mfma_f32_16x16x32_bf16 v[184:187], v[44:47], v[36:39], v[184:187]
    s_waitcnt lgkmcnt(0)
    s_barrier
    v_mfma_f32_16x16x32_bf16 v[104:107], v[48:51], v[24:27], v[104:107]
    ds_read_b128 v[8:11], v68 offset:0
    v_mfma_f32_16x16x32_bf16 v[132:135], v[48:51], v[28:31], v[132:135]
    ds_read_b128 v[12:15], v68 offset:2048
    v_mfma_f32_16x16x32_bf16 v[160:163], v[48:51], v[32:35], v[160:163]
    ds_read_b128 v[16:19], v68 offset:4096
    v_mfma_f32_16x16x32_bf16 v[188:191], v[48:51], v[36:39], v[188:191]
    ds_read_b128 v[20:23], v68 offset:6144
    v_mfma_f32_16x16x32_bf16 v[108:111], v[52:55], v[24:27], v[108:111]
    ds_read_b64_tr_b16 v[40:41], v72 offset:40960
    v_mfma_f32_16x16x32_bf16 v[136:139], v[52:55], v[28:31], v[136:139]
    ds_read_b64_tr_b16 v[42:43], v72 offset:41216
    v_mfma_f32_16x16x32_bf16 v[164:167], v[52:55], v[32:35], v[164:167]
    ds_read_b64_tr_b16 v[44:45], v70 offset:16384
    v_mfma_f32_16x16x32_bf16 v[192:195], v[52:55], v[36:39], v[192:195]
    ds_read_b64_tr_b16 v[46:47], v70 offset:17152
    v_mfma_f32_16x16x32_bf16 v[112:115], v[56:59], v[24:27], v[112:115]
    ds_read_b64_tr_b16 v[48:49], v71 offset:16384
    v_mfma_f32_16x16x32_bf16 v[140:143], v[56:59], v[28:31], v[140:143]
    ds_read_b64_tr_b16 v[50:51], v71 offset:17152
    v_mfma_f32_16x16x32_bf16 v[168:171], v[56:59], v[32:35], v[168:171]
    ds_read_b64_tr_b16 v[52:53], v70 offset:16448
    v_mfma_f32_16x16x32_bf16 v[196:199], v[56:59], v[36:39], v[196:199]
    ds_read_b64_tr_b16 v[54:55], v70 offset:17216
    v_mfma_f32_16x16x32_bf16 v[116:119], v[60:63], v[24:27], v[116:119]
    ds_read_b64_tr_b16 v[56:57], v70 offset:28672
    v_mfma_f32_16x16x32_bf16 v[144:147], v[60:63], v[28:31], v[144:147]
    ds_read_b64_tr_b16 v[58:59], v70 offset:29440
    v_mfma_f32_16x16x32_bf16 v[172:175], v[60:63], v[32:35], v[172:175]
    v_mfma_f32_16x16x32_bf16 v[200:203], v[60:63], v[36:39], v[200:203]
    v_mfma_f32_16x16x32_bf16 v[120:123], v[64:67], v[24:27], v[120:123]
    ds_read_b64_tr_b16 v[60:61], v71 offset:28672
    v_mfma_f32_16x16x32_bf16 v[148:151], v[64:67], v[28:31], v[148:151]
    ds_read_b64_tr_b16 v[62:63], v71 offset:29440
    v_mfma_f32_16x16x32_bf16 v[176:179], v[64:67], v[32:35], v[176:179]
    v_mfma_f32_16x16x32_bf16 v[204:207], v[64:67], v[36:39], v[204:207]
    ds_read_b64_tr_b16 v[64:65], v70 offset:28736
    ds_read_b64_tr_b16 v[66:67], v70 offset:29504
    s_cmp_lt_u32 s55, 8
    s_cbranch_scc1 Lc_2
    ds_read_b128 v[40:43], v74 offset:0
    ds_read_b128 v[44:47], v74 offset:256
    ds_read_b128 v[48:51], v74 offset:512
    ds_read_b128 v[52:55], v74 offset:768
    ds_read_b128 v[8:11], v212 offset:0
    ds_read_b128 v[12:15], v212 offset:64
    ds_read_b128 v[16:19], v212 offset:128
    ds_read_b128 v[20:23], v212 offset:192
    ds_read_b128 v[24:27], v212 offset:256
    ds_read_b128 v[28:31], v212 offset:320
    ds_read_b128 v[32:35], v212 offset:384
    s_waitcnt lgkmcnt(6)
    v_mul_f32 v56, 0xbe206c99, v41
    v_mul_f32 v57, 0xbe206c99, v45
    v_mul_f32 v58, 0xbe206c99, v49
    v_mul_f32 v59, 0xbe206c99, v53
    v_fma_f32 v96, v40, v8, v96
    v_fma_f32 v97, v40, v9, v97
    v_fma_f32 v98, v40, v10, v98
    v_fma_f32 v99, v40, v11, v99
    v_fma_f32 v124, v44, v8, v124
    v_fma_f32 v125, v44, v9, v125
    v_fma_f32 v126, v44, v10, v126
    v_fma_f32 v127, v44, v11, v127
    v_fma_f32 v152, v48, v8, v152
    v_fma_f32 v153, v48, v9, v153
    v_fma_f32 v154, v48, v10, v154
    v_fma_f32 v155, v48, v11, v155
    v_fma_f32 v180, v52, v8, v180
    v_fma_f32 v181, v52, v9, v181
    v_fma_f32 v182, v52, v10, v182
    v_fma_f32 v183, v52, v11, v183
    v_mul_f32 v96, v96, v56
    v_mul_f32 v97, v97, v56
    v_mul_f32 v98, v98, v56
    v_mul_f32 v99, v99, v56
    v_mul_f32 v124, v124, v57
    v_mul_f32 v125, v125, v57
    v_mul_f32 v126, v126, v57
    v_mul_f32 v127, v127, v57
    v_mul_f32 v152, v152, v58
    v_mul_f32 v153, v153, v58
    v_mul_f32 v154, v154, v58
    v_mul_f32 v155, v155, v58
    v_mul_f32 v180, v180, v59
    v_mul_f32 v181, v181, v59
    v_mul_f32 v182, v182, v59
    v_mul_f32 v183, v183, v59
    v_cvt_pk_bf16_f32 v96, v96, v97
    v_cvt_pk_bf16_f32 v97, v98, v99
    v_cvt_pk_bf16_f32 v124, v124, v125
    v_cvt_pk_bf16_f32 v125, v126, v127
    v_cvt_pk_bf16_f32 v152, v152, v153
    v_cvt_pk_bf16_f32 v153, v154, v155
    v_cvt_pk_bf16_f32 v180, v180, v181
    v_cvt_pk_bf16_f32 v181, v182, v183
    ds_write_b64 v75, v[96:97] offset:0
    ds_write_b64 v75, v[124:125] offset:256
    ds_write_b64 v75, v[152:153] offset:2048
    ds_write_b64 v75, v[180:181] offset:2304
    v_mov_b32 v3, 163776
    s_waitcnt lgkmcnt(0)
    s_barrier
    ds_read_b32 v4, v3 offset:16
    s_waitcnt lgkmcnt(0)
    v_cmp_ne_u32 vcc, 0, v4
    s_cmp_eq_u64 vcc, 0
    s_cselect_b32 s55, 1, 0
    s_lshl_b32 s58, s47, 12
    v_fmac_f32 v100, v40, v12
    v_fmac_f32 v101, v40, v13
    v_fmac_f32 v102, v40, v14
    v_fmac_f32 v103, v40, v15
    v_fmac_f32 v104, v40, v16
    v_fmac_f32 v105, v40, v17
    v_fmac_f32 v106, v40, v18
    v_fmac_f32 v107, v40, v19
    v_fmac_f32 v108, v40, v20
    v_fmac_f32 v109, v40, v21
    v_fmac_f32 v110, v40, v22
    v_fmac_f32 v111, v40, v23
    v_fmac_f32 v112, v40, v24
    v_fmac_f32 v113, v40, v25
    v_fmac_f32 v114, v40, v26
    v_fmac_f32 v115, v40, v27
    v_fmac_f32 v116, v40, v28
    v_fmac_f32 v117, v40, v29
    v_fmac_f32 v118, v40, v30
    v_fmac_f32 v119, v40, v31
    v_fmac_f32 v120, v40, v32
    v_fmac_f32 v121, v40, v33
    v_fmac_f32 v122, v40, v34
    v_fmac_f32 v123, v40, v35
    v_mul_f32 v56, v100, v100
    v_mul_f32 v57, v101, v101
    v_mul_f32 v58, v102, v102
    v_mul_f32 v59, v103, v103
    v_mul_f32 v60, v104, v104
    v_mul_f32 v61, v105, v105
    v_mul_f32 v62, v106, v106
    v_mul_f32 v63, v107, v107
    v_mul_f32 v64, v108, v108
    v_mul_f32 v65, v109, v109
    s_cbranch_vccz Lgk0
    s_add_u32 s57, s58, 36864
    s_mov_b32 m0, s57
    s_nop 0
    buffer_load_dwordx4 v244, s[40:43], s57 offen offset:0 sc1 lds
    buffer_load_dwordx4 v244, s[40:43], s57 offen offset:1024 sc1 lds
Lgk0:
    v_mul_f32 v66, v110, v110
    v_mul_f32 v67, v111, v111
    v_fma_f32 v56, v56, v42, v41
    v_fma_f32 v57, v57, v42, v41
    v_fma_f32 v58, v58, v42, v41
    v_fma_f32 v59, v59, v42, v41
    v_fma_f32 v60, v60, v42, v41
    v_fma_f32 v61, v61, v42, v41
    v_fma_f32 v62, v62, v42, v41
    v_fma_f32 v63, v63, v42, v41
    v_fma_f32 v64, v64, v42, v41
    v_fma_f32 v65, v65, v42, v41
    v_fma_f32 v66, v66, v42, v41
    v_fma_f32 v67, v67, v42, v41
    v_mul_f32 v56, v56, v100
    v_mul_f32 v57, v57, v101
    v_mul_f32 v58, v58, v102
    v_mul_f32 v59, v59, v103
    v_mul_f32 v60, v60, v104
    v_mul_f32 v61, v61, v105
    v_mul_f32 v62, v62, v106
    v_mul_f32 v63, v63, v107
    v_mul_f32 v64, v64, v108
    v_mul_f32 v65, v65, v109
    v_mul_f32 v66, v66, v110
    v_mul_f32 v67, v67, v111
    v_exp_f32 v56, v56
    v_exp_f32 v57, v57
    v_exp_f32 v58, v58
    v_exp_f32 v59, v59
    v_exp_f32 v60, v60
    v_exp_f32 v61, v61
    v_exp_f32 v62, v62
    s_cbranch_vccz Lgk1
    buffer_load_dwordx4 v244, s[40:43], s57 offen offset:2048 sc1 lds
    buffer_load_dwordx4 v244, s[40:43], s57 offen offset:3072 sc1 lds
Lgk1:
    v_exp_f32 v63, v63
    v_exp_f32 v64, v64
    v_exp_f32 v65, v65
    v_exp_f32 v66, v66
    v_exp_f32 v67, v67
    v_mul_f32 v112, v112, v100
    v_mul_f32 v113, v113, v101
    v_mul_f32 v114, v114, v102
    v_mul_f32 v115, v115, v103
    v_mul_f32 v116, v116, v104
    v_mul_f32 v117, v117, v105
    v_mul_f32 v118, v118, v106
    v_mul_f32 v119, v119, v107
    v_mul_f32 v120, v120, v108
    v_mul_f32 v121, v121, v109
    v_mul_f32 v122, v122, v110
    v_mul_f32 v123, v123, v111
    v_fma_f32 v56, v56, v43, v43
    v_fma_f32 v57, v57, v43, v43
    v_fma_f32 v58, v58, v43, v43
    v_fma_f32 v59, v59, v43, v43
    v_fma_f32 v60, v60, v43, v43
    v_fma_f32 v61, v61, v43, v43
    v_fma_f32 v62, v62, v43, v43
    v_fma_f32 v63, v63, v43, v43
    v_fma_f32 v64, v64, v43, v43
    v_fma_f32 v65, v65, v43, v43
    v_fma_f32 v66, v66, v43, v43
    v_fma_f32 v67, v67, v43, v43
    v_rcp_f32 v56, v56
    v_rcp_f32 v57, v57
    v_rcp_f32 v58, v58
    v_rcp_f32 v59, v59
    s_cbranch_vccz Lgk2
    s_add_u32 s57, s58, 53248
    s_mov_b32 m0, s57
    s_nop 0
    buffer_load_dwordx4 v244, s[40:43], s57 offen offset:0 sc1 lds
    buffer_load_dwordx4 v244, s[40:43], s57 offen offset:1024 sc1 lds
Lgk2:
    v_rcp_f32 v60, v60
    v_rcp_f32 v61, v61
    v_rcp_f32 v62, v62
    v_rcp_f32 v63, v63
    v_rcp_f32 v64, v64
    v_rcp_f32 v65, v65
    v_rcp_f32 v66, v66
    v_rcp_f32 v67, v67
    s_nop 0
    v_mul_f32 v112, v112, v56
    v_mul_f32 v113, v113, v57
    v_mul_f32 v114, v114, v58
    v_mul_f32 v115, v115, v59
    v_mul_f32 v116, v116, v60
    v_mul_f32 v117, v117, v61
    v_mul_f32 v118, v118, v62
    v_mul_f32 v119, v119, v63
    v_mul_f32 v120, v120, v64
    v_mul_f32 v121, v121, v65
    v_mul_f32 v122, v122, v66
    v_mul_f32 v123, v123, v67
    v_cvt_pk_bf16_f32 v100, v112, v113
    v_cvt_pk_bf16_f32 v101, v114, v115
    v_cvt_pk_bf16_f32 v104, v116, v117
    v_cvt_pk_bf16_f32 v105, v118, v119
    v_cvt_pk_bf16_f32 v108, v120, v121
    v_cvt_pk_bf16_f32 v109, v122, v123
    s_cmp_lg_u32 s55, 0
    s_cbranch_scc1 Lck0
Lckr0:
    v_fmac_f32 v128, v44, v12
    v_fmac_f32 v129, v44, v13
    v_fmac_f32 v130, v44, v14
    v_fmac_f32 v131, v44, v15
    v_fmac_f32 v132, v44, v16
    s_cbranch_vccz Lgk3
    buffer_load_dwordx4 v244, s[40:43], s57 offen offset:2048 sc1 lds
    buffer_load_dwordx4 v244, s[40:43], s57 offen offset:3072 sc1 lds
Lgk3:
    v_fmac_f32 v133, v44, v17
    v_fmac_f32 v134, v44, v18
    v_fmac_f32 v135, v44, v19
    v_fmac_f32 v136, v44, v20
    v_fmac_f32 v137, v44, v21
    v_fmac_f32 v138, v44, v22
    v_fmac_f32 v139, v44, v23
    v_fmac_f32 v140, v44, v24
    v_fmac_f32 v141, v44, v25
    v_fmac_f32 v142, v44, v26
    v_fmac_f32 v143, v44, v27
    v_fmac_f32 v144, v44, v28
    v_fmac_f32 v145, v44, v29
    v_fmac_f32 v146, v44, v30
    v_fmac_f32 v147, v44, v31
    v_fmac_f32 v148, v44, v32
    v_fmac_f32 v149, v44, v33
    v_fmac_f32 v150, v44, v34
    v_fmac_f32 v151, v44, v35
    v_mul_f32 v56, v128, v128
    v_mul_f32 v57, v129, v129
    v_mul_f32 v58, v130, v130
    v_mul_f32 v59, v131, v131
    v_mul_f32 v60, v132, v132
    v_mul_f32 v61, v133, v133
    v_mul_f32 v62, v134, v134
    v_mul_f32 v63, v135, v135
    v_mul_f32 v64, v136, v136
    v_mul_f32 v65, v137, v137
    v_mul_f32 v66, v138, v138
    v_mul_f32 v67, v139, v139
    v_fma_f32 v56, v56, v46, v45
    v_fma_f32 v57, v57, v46, v45
    s_cbranch_vccz Lgk4
    s_add_u32 s57, s58, 69632
    s_mov_b32 m0, s57
    s_nop 0
    buffer_load_dwordx4 v244, s[40:43], s57 offen offset:0 sc1 lds
    buffer_load_dwordx4 v244, s[40:43], s57 offen offset:1024 sc1 lds
Lgk4:
    v_fma_f32 v58, v58, v46, v45
    v_fma_f32 v59, v59, v46, v45
    v_fma_f32 v60, v60, v46, v45
    v_fma_f32 v61, v61, v46, v45
    v_fma_f32 v62, v62, v46, v45
    v_fma_f32 v63, v63, v46, v45
    v_fma_f32 v64, v64, v46, v45
    v_fma_f32 v65, v65, v46, v45
    v_fma_f32 v66, v66, v46, v45
    v_fma_f32 v67, v67, v46, v45
    v_mul_f32 v56, v56, v128
    v_mul_f32 v57, v57, v129
    v_mul_f32 v58, v58, v130
    v_mul_f32 v59, v59, v131
    v_mul_f32 v60, v60, v132
    v_mul_f32 v61, v61, v133
    v_mul_f32 v62, v62, v134
    v_mul_f32 v63, v63, v135
    v_mul_f32 v64, v64, v136
    v_mul_f32 v65, v65, v137
    v_mul_f32 v66, v66, v138
    v_mul_f32 v67, v67, v139
    v_exp_f32 v56, v56
    v_exp_f32 v57, v57
    v_exp_f32 v58, v58
    v_exp_f32 v59, v59
    v_exp_f32 v60, v60
    v_exp_f32 v61, v61
    v_exp_f32 v62, v62
    v_exp_f32 v63, v63
    v_exp_f32 v64, v64
    v_exp_f32 v65, v65
    v_exp_f32 v66, v66
    s_cbranch_vccz Lgk5
    buffer_load_dwordx4 v244, s[40:43], s57 offen offset:2048 sc1 lds
    buffer_load_dwordx4 v244, s[40:43], s57 offen offset:3072 sc1 lds
Lgk5:
    v_exp_f32 v67, v67
    v_mul_f32 v140, v140, v128
    v_mul_f32 v141, v141, v129
    v_mul_f32 v142, v142, v130
    v_mul_f32 v143, v143, v131
    v_mul_f32 v144, v144, v132
    v_mul_f32 v145, v145, v133
    v_mul_f32 v146, v146, v134
    v_mul_f32 v147, v147, v135
    v_mul_f32 v148, v148, v136
    v_mul_f32 v149, v149, v137
    v_mul_f32 v150, v150, v138
    v_mul_f32 v151, v151, v139
    v_fma_f32 v56, v56, v47, v47
    v_fma_f32 v57, v57, v47, v47
    v_fma_f32 v58, v58, v47, v47
    v_fma_f32 v59, v59, v47, v47
    v_fma_f32 v60, v60, v47, v47
    v_fma_f32 v61, v61, v47, v47
    v_fma_f32 v62, v62, v47, v47
    v_fma_f32 v63, v63, v47, v47
    v_fma_f32 v64, v64, v47, v47
    v_fma_f32 v65, v65, v47, v47
    v_fma_f32 v66, v66, v47, v47
    v_fma_f32 v67, v67, v47, v47
    v_rcp_f32 v56, v56
    v_rcp_f32 v57, v57
    v_rcp_f32 v58, v58
    v_rcp_f32 v59, v59
    v_rcp_f32 v60, v60
    v_rcp_f32 v61, v61
    v_rcp_f32 v62, v62
    v_rcp_f32 v63, v63
    v_rcp_f32 v64, v64
    s_cbranch_vccz Lgk6
    s_add_u32 s57, s58, 86016
    s_mov_b32 m0, s57
    s_nop 0
    buffer_load_dwordx4 v244, s[40:43], s57 offen offset:0 sc1 lds
    buffer_load_dwordx4 v244, s[40:43], s57 offen offset:1024 sc1 lds
Lgk6:
    v_rcp_f32 v65, v65
    v_rcp_f32 v66, v66
    v_rcp_f32 v67, v67
    s_nop 0
    v_mul_f32 v140, v140, v56
    v_mul_f32 v141, v141, v57
    v_mul_f32 v142, v142, v58
    v_mul_f32 v143, v143, v59
    v_mul_f32 v144, v144, v60
    v_mul_f32 v145, v145, v61
    v_mul_f32 v146, v146, v62
    v_mul_f32 v147, v147, v63
    v_mul_f32 v148, v148, v64
    v_mul_f32 v149, v149, v65
    v_mul_f32 v150, v150, v66
    v_mul_f32 v151, v151, v67
    v_cvt_pk_bf16_f32 v102, v140, v141
    v_cvt_pk_bf16_f32 v103, v142, v143
    v_cvt_pk_bf16_f32 v106, v144, v145
    v_cvt_pk_bf16_f32 v107, v146, v147
    v_cvt_pk_bf16_f32 v110, v148, v149
    v_cvt_pk_bf16_f32 v111, v150, v151
    s_nop 0
    v_permlane32_swap_b32 v100, v102
    v_permlane32_swap_b32 v101, v103
    v_permlane32_swap_b32 v104, v106
    v_permlane32_swap_b32 v105, v107
    v_permlane32_swap_b32 v108, v110
    v_permlane32_swap_b32 v109, v111
    s_cmp_eq_u32 s94, 8460288
    s_cbranch_scc1 Lns10
    buffer_store_dwordx4 v[100:103], v73, s[40:43], s94 offen sc1
Lns10:
    s_cmp_eq_u32 s95, 8460288
    s_cbranch_scc1 Lns11
    buffer_store_dwordx4 v[104:107], v73, s[40:43], s95 offen sc1
Lns11:
    s_cmp_eq_u32 s96, 8460288
    s_cbranch_scc1 Lns12
    buffer_store_dwordx4 v[108:111], v73, s[40:43], s96 offen sc1
Lns12:
    s_cmp_lg_u32 s55, 0
    s_cbranch_scc1 Lck1
Lckr1:
    s_cbranch_vccz Lgk7
    buffer_load_dwordx4 v244, s[40:43], s57 offen offset:2048 sc1 lds
    buffer_load_dwordx4 v244, s[40:43], s57 offen offset:3072 sc1 lds
Lgk7:
    v_fmac_f32 v156, v48, v12
    v_fmac_f32 v157, v48, v13
    v_fmac_f32 v158, v48, v14
    v_fmac_f32 v159, v48, v15
    v_fmac_f32 v160, v48, v16
    v_fmac_f32 v161, v48, v17
    v_fmac_f32 v162, v48, v18
    v_fmac_f32 v163, v48, v19
    v_fmac_f32 v164, v48, v20
    v_fmac_f32 v165, v48, v21
    v_fmac_f32 v166, v48, v22
    v_fmac_f32 v167, v48, v23
    v_fmac_f32 v168, v48, v24
    v_fmac_f32 v169, v48, v25
    v_fmac_f32 v170, v48, v26
    v_fmac_f32 v171, v48, v27
    v_fmac_f32 v172, v48, v28
    v_fmac_f32 v173, v48, v29
    v_fmac_f32 v174, v48, v30
    v_fmac_f32 v175, v48, v31
    v_fmac_f32 v176, v48, v32
    v_fmac_f32 v177, v48, v33
    v_fmac_f32 v178, v48, v34
    v_fmac_f32 v179, v48, v35
    v_mul_f32 v56, v156, v156
    v_mul_f32 v57, v157, v157
    v_mul_f32 v58, v158, v158
    v_mul_f32 v59, v159, v159
    v_mul_f32 v60, v160, v160
    v_mul_f32 v61, v161, v161
    v_mul_f32 v62, v162, v162
    v_mul_f32 v63, v163, v163
    v_mul_f32 v64, v164, v164
    s_cbranch_vccz Lgk8
    s_add_u32 s57, s58, 102400
    s_mov_b32 m0, s57
    s_nop 0
    buffer_load_dwordx4 v244, s[40:43], s57 offen offset:0 sc1 lds
    buffer_load_dwordx4 v244, s[40:43], s57 offen offset:1024 sc1 lds
Lgk8:
    v_mul_f32 v65, v165, v165
    v_mul_f32 v66, v166, v166
    v_mul_f32 v67, v167, v167
    v_fma_f32 v56, v56, v50, v49
    v_fma_f32 v57, v57, v50, v49
    v_fma_f32 v58, v58, v50, v49
    v_fma_f32 v59, v59, v50, v49
    v_fma_f32 v60, v60, v50, v49
    v_fma_f32 v61, v61, v50, v49
    v_fma_f32 v62, v62, v50, v49
    v_fma_f32 v63, v63, v50, v49
    v_fma_f32 v64, v64, v50, v49
    v_fma_f32 v65, v65, v50, v49
    v_fma_f32 v66, v66, v50, v49
    v_fma_f32 v67, v67, v50, v49
    v_mul_f32 v56, v56, v156
    v_mul_f32 v57, v57, v157
    v_mul_f32 v58, v58, v158
    v_mul_f32 v59, v59, v159
    v_mul_f32 v60, v60, v160
    v_mul_f32 v61, v61, v161
    v_mul_f32 v62, v62, v162
    v_mul_f32 v63, v63, v163
    v_mul_f32 v64, v64, v164
    v_mul_f32 v65, v65, v165
    v_mul_f32 v66, v66, v166
    v_mul_f32 v67, v67, v167
    v_exp_f32 v56, v56
    v_exp_f32 v57, v57
    v_exp_f32 v58, v58
    v_exp_f32 v59, v59
    v_exp_f32 v60, v60
    v_exp_f32 v61, v61
    s_cbranch_vccz Lgk9
    buffer_load_dwordx4 v244, s[40:43], s57 offen offset:2048 sc1 lds
    buffer_load_dwordx4 v244, s[40:43], s57 offen offset:3072 sc1 lds
Lgk9:
    v_exp_f32 v62, v62
    v_exp_f32 v63, v63
    v_exp_f32 v64, v64
    v_exp_f32 v65, v65
    v_exp_f32 v66, v66
    v_exp_f32 v67, v67
    v_mul_f32 v168, v168, v156
    v_mul_f32 v169, v169, v157
    v_mul_f32 v170, v170, v158
    v_mul_f32 v171, v171, v159
    v_mul_f32 v172, v172, v160
    v_mul_f32 v173, v173, v161
    v_mul_f32 v174, v174, v162
    v_mul_f32 v175, v175, v163
    v_mul_f32 v176, v176, v164
    v_mul_f32 v177, v177, v165
    v_mul_f32 v178, v178, v166
    v_mul_f32 v179, v179, v167
    v_fma_f32 v56, v56, v51, v51
    v_fma_f32 v57, v57, v51, v51
    v_fma_f32 v58, v58, v51, v51
    v_fma_f32 v59, v59, v51, v51
    v_fma_f32 v60, v60, v51, v51
    v_fma_f32 v61, v61, v51, v51
    v_fma_f32 v62, v62, v51, v51
    v_fma_f32 v63, v63, v51, v51
    v_fma_f32 v64, v64, v51, v51
    v_fma_f32 v65, v65, v51, v51
    v_fma_f32 v66, v66, v51, v51
    v_fma_f32 v67, v67, v51, v51
    v_rcp_f32 v56, v56
    v_rcp_f32 v57, v57
    v_rcp_f32 v58, v58
    s_cbranch_vccz Lgk10
    s_add_u32 s57, s58, 118784
    s_mov_b32 m0, s57
    s_nop 0
    buffer_load_dwordx4 v244, s[40:43], s57 offen offset:0 sc1 lds
    buffer_load_dwordx4 v244, s[40:43], s57 offen offset:1024 sc1 lds
Lgk10:
    v_rcp_f32 v59, v59
    v_rcp_f32 v60, v60
    v_rcp_f32 v61, v61
    v_rcp_f32 v62, v62
    v_rcp_f32 v63, v63
    v_rcp_f32 v64, v64
    v_rcp_f32 v65, v65
    v_rcp_f32 v66, v66
    v_rcp_f32 v67, v67
    s_nop 0
    v_mul_f32 v168, v168, v56
    v_mul_f32 v169, v169, v57
    v_mul_f32 v170, v170, v58
    v_mul_f32 v171, v171, v59
    v_mul_f32 v172, v172, v60
    v_mul_f32 v173, v173, v61
    v_mul_f32 v174, v174, v62
    v_mul_f32 v175, v175, v63
    v_mul_f32 v176, v176, v64
    v_mul_f32 v177, v177, v65
    v_mul_f32 v178, v178, v66
    v_mul_f32 v179, v179, v67
    v_cvt_pk_bf16_f32 v156, v168, v169
    v_cvt_pk_bf16_f32 v157, v170, v171
    v_cvt_pk_bf16_f32 v160, v172, v173
    v_cvt_pk_bf16_f32 v161, v174, v175
    v_cvt_pk_bf16_f32 v164, v176, v177
    v_cvt_pk_bf16_f32 v165, v178, v179
    s_cmp_lg_u32 s55, 0
    s_cbranch_scc1 Lck2
Lckr2:
    v_fmac_f32 v184, v52, v12
    v_fmac_f32 v185, v52, v13
    v_fmac_f32 v186, v52, v14
    v_fmac_f32 v187, v52, v15
    s_cbranch_vccz Lgk11
    buffer_load_dwordx4 v244, s[40:43], s57 offen offset:2048 sc1 lds
    buffer_load_dwordx4 v244, s[40:43], s57 offen offset:3072 sc1 lds
Lgk11:
    v_fmac_f32 v188, v52, v16
    v_fmac_f32 v189, v52, v17
    v_fmac_f32 v190, v52, v18
    v_fmac_f32 v191, v52, v19
    v_fmac_f32 v192, v52, v20
    v_fmac_f32 v193, v52, v21
    v_fmac_f32 v194, v52, v22
    v_fmac_f32 v195, v52, v23
    v_fmac_f32 v196, v52, v24
    v_fmac_f32 v197, v52, v25
    v_fmac_f32 v198, v52, v26
    v_fmac_f32 v199, v52, v27
    v_fmac_f32 v200, v52, v28
    v_fmac_f32 v201, v52, v29
    v_fmac_f32 v202, v52, v30
    v_fmac_f32 v203, v52, v31
    v_fmac_f32 v204, v52, v32
    v_fmac_f32 v205, v52, v33
    v_fmac_f32 v206, v52, v34
    v_fmac_f32 v207, v52, v35
    v_mul_f32 v56, v184, v184
    v_mul_f32 v57, v185, v185
    v_mul_f32 v58, v186, v186
    v_mul_f32 v59, v187, v187
    v_mul_f32 v60, v188, v188
    v_mul_f32 v61, v189, v189
    v_mul_f32 v62, v190, v190
    v_mul_f32 v63, v191, v191
    v_mul_f32 v64, v192, v192
    v_mul_f32 v65, v193, v193
    v_mul_f32 v66, v194, v194
    v_mul_f32 v67, v195, v195
    v_fma_f32 v56, v56, v54, v53
    v_fma_f32 v57, v57, v54, v53
    v_fma_f32 v58, v58, v54, v53
    v_fma_f32 v59, v59, v54, v53
    v_fma_f32 v60, v60, v54, v53
    v_fma_f32 v61, v61, v54, v53
    v_fma_f32 v62, v62, v54, v53
    v_fma_f32 v63, v63, v54, v53
    v_fma_f32 v64, v64, v54, v53
    v_fma_f32 v65, v65, v54, v53
    v_fma_f32 v66, v66, v54, v53
    v_fma_f32 v67, v67, v54, v53
    v_mul_f32 v56, v56, v184
    v_mul_f32 v57, v57, v185
    v_mul_f32 v58, v58, v186
    v_mul_f32 v59, v59, v187
    v_mul_f32 v60, v60, v188
    v_mul_f32 v61, v61, v189
    v_mul_f32 v62, v62, v190
    v_mul_f32 v63, v63, v191
    v_mul_f32 v64, v64, v192
    v_mul_f32 v65, v65, v193
    v_mul_f32 v66, v66, v194
    v_mul_f32 v67, v67, v195
    v_exp_f32 v56, v56
    v_exp_f32 v57, v57
    v_exp_f32 v58, v58
    v_exp_f32 v59, v59
    v_exp_f32 v60, v60
    v_exp_f32 v61, v61
    v_exp_f32 v62, v62
    v_exp_f32 v63, v63
    v_exp_f32 v64, v64
    v_exp_f32 v65, v65
    v_exp_f32 v66, v66
    v_exp_f32 v67, v67
    v_mul_f32 v196, v196, v184
    v_mul_f32 v197, v197, v185
    v_mul_f32 v198, v198, v186
    v_mul_f32 v199, v199, v187
    v_mul_f32 v200, v200, v188
    v_mul_f32 v201, v201, v189
    v_mul_f32 v202, v202, v190
    v_mul_f32 v203, v203, v191
    v_mul_f32 v204, v204, v192
    v_mul_f32 v205, v205, v193
    v_mul_f32 v206, v206, v194
    v_mul_f32 v207, v207, v195
    v_fma_f32 v56, v56, v55, v55
    v_fma_f32 v57, v57, v55, v55
    v_fma_f32 v58, v58, v55, v55
    v_fma_f32 v59, v59, v55, v55
    v_fma_f32 v60, v60, v55, v55
    v_fma_f32 v61, v61, v55, v55
    v_fma_f32 v62, v62, v55, v55
    v_fma_f32 v63, v63, v55, v55
    v_fma_f32 v64, v64, v55, v55
    v_fma_f32 v65, v65, v55, v55
    v_fma_f32 v66, v66, v55, v55
    v_fma_f32 v67, v67, v55, v55
    v_rcp_f32 v56, v56
    v_rcp_f32 v57, v57
    v_rcp_f32 v58, v58
    v_rcp_f32 v59, v59
    v_rcp_f32 v60, v60
    v_rcp_f32 v61, v61
    v_rcp_f32 v62, v62
    v_rcp_f32 v63, v63
    v_rcp_f32 v64, v64
    v_rcp_f32 v65, v65
    v_rcp_f32 v66, v66
    v_rcp_f32 v67, v67
    s_nop 0
    v_mul_f32 v196, v196, v56
    v_mul_f32 v197, v197, v57
    v_mul_f32 v198, v198, v58
    v_mul_f32 v199, v199, v59
    v_mul_f32 v200, v200, v60
    v_mul_f32 v201, v201, v61
    v_mul_f32 v202, v202, v62
    v_mul_f32 v203, v203, v63
    v_mul_f32 v204, v204, v64
    v_mul_f32 v205, v205, v65
    v_mul_f32 v206, v206, v66
    v_mul_f32 v207, v207, v67
    v_cvt_pk_bf16_f32 v158, v196, v197
    v_cvt_pk_bf16_f32 v159, v198, v199
    v_cvt_pk_bf16_f32 v162, v200, v201
    v_cvt_pk_bf16_f32 v163, v202, v203
    v_cvt_pk_bf16_f32 v166, v204, v205
    v_cvt_pk_bf16_f32 v167, v206, v207
    s_nop 0
    v_permlane32_swap_b32 v156, v158
    v_permlane32_swap_b32 v157, v159
    v_permlane32_swap_b32 v160, v162
    v_permlane32_swap_b32 v161, v163
    v_permlane32_swap_b32 v164, v166
    v_permlane32_swap_b32 v165, v167
    s_cmp_eq_u32 s94, 8460288
    s_cbranch_scc1 Lns30
    buffer_store_dwordx4 v[156:159], v214, s[40:43], s94 offen sc1
Lns30:
    s_cmp_eq_u32 s95, 8460288
    s_cbranch_scc1 Lns31
    buffer_store_dwordx4 v[160:163], v214, s[40:43], s95 offen sc1
Lns31:
    s_cmp_eq_u32 s96, 8460288
    s_cbranch_scc1 Lns32
    buffer_store_dwordx4 v[164:167], v214, s[40:43], s96 offen sc1
Lns32:
    s_cmp_eq_u32 s55, 0
    s_cbranch_scc1 Lgk
    s_mov_b32 s57, 0
    s_setprio 0
Lgw:
    s_sleep 2
    ds_read_b32 v4, v3 offset:16
    s_add_u32 s57, s57, 1
    s_waitcnt lgkmcnt(0)
    v_cmp_ne_u32 vcc, 0, v4
    s_cmp_ge_u32 s57, 2000000
    s_cbranch_scc1 LFkv
    s_cbranch_vccz Lgw
    s_branch LFkv
Lgk:
    buffer_load_dwordx2 v[246:247], off, s[36:39], 0 sc1
    s_branch LF
Lck0:
    ds_read_b32 v4, v3 offset:16
    s_waitcnt lgkmcnt(0)
    v_readfirstlane_b32 s59, v4
    s_cmp_eq_u32 s59, 0
    s_cbranch_scc1 Lckr0
    s_mov_b32 s55, 0
    s_setprio 0
    s_lshl_b32 s58, s47, 12
    s_add_u32 s57, s58, 36864
    s_mov_b32 m0, s57
    s_nop 0
    buffer_load_dwordx4 v244, s[40:43], s57 offen offset:0 sc1 lds
    buffer_load_dwordx4 v244, s[40:43], s57 offen offset:1024 sc1 lds
    buffer_load_dwordx4 v244, s[40:43], s57 offen offset:2048 sc1 lds
    buffer_load_dwordx4 v244, s[40:43], s57 offen offset:3072 sc1 lds
    s_add_u32 s57, s58, 53248
    s_mov_b32 m0, s57
    s_nop 0
    buffer_load_dwordx4 v244, s[40:43], s57 offen offset:0 sc1 lds
    buffer_load_dwordx4 v244, s[40:43], s57 offen offset:1024 sc1 lds
    buffer_load_dwordx4 v244, s[40:43], s57 offen offset:2048 sc1 lds
    buffer_load_dwordx4 v244, s[40:43], s57 offen offset:3072 sc1 lds
    s_add_u32 s57, s58, 69632
    s_mov_b32 m0, s57
    s_nop 0
    buffer_load_dwordx4 v244, s[40:43], s57 offen offset:0 sc1 lds
    buffer_load_dwordx4 v244, s[40:43], s57 offen offset:1024 sc1 lds
    buffer_load_dwordx4 v244, s[40:43], s57 offen offset:2048 sc1 lds
    buffer_load_dwordx4 v244, s[40:43], s57 offen offset:3072 sc1 lds
    s_add_u32 s57, s58, 86016
    s_mov_b32 m0, s57
    s_nop 0
    buffer_load_dwordx4 v244, s[40:43], s57 offen offset:0 sc1 lds
    buffer_load_dwordx4 v244, s[40:43], s57 offen offset:1024 sc1 lds
    buffer_load_dwordx4 v244, s[40:43], s57 offen offset:2048 sc1 lds
    buffer_load_dwordx4 v244, s[40:43], s57 offen offset:3072 sc1 lds
    s_add_u32 s57, s58, 102400
    s_mov_b32 m0, s57
    s_nop 0
    buffer_load_dwordx4 v244, s[40:43], s57 offen offset:0 sc1 lds
    buffer_load_dwordx4 v244, s[40:43], s57 offen offset:1024 sc1 lds
    buffer_load_dwordx4 v244, s[40:43], s57 offen offset:2048 sc1 lds
    buffer_load_dwordx4 v244, s[40:43], s57 offen offset:3072 sc1 lds
    s_add_u32 s57, s58, 118784
    s_mov_b32 m0, s57
    s_nop 0
    buffer_load_dwordx4 v244, s[40:43], s57 offen offset:0 sc1 lds
    buffer_load_dwordx4 v244, s[40:43], s57 offen offset:1024 sc1 lds
    buffer_load_dwordx4 v244, s[40:43], s57 offen offset:2048 sc1 lds
    buffer_load_dwordx4 v244, s[40:43], s57 offen offset:3072 sc1 lds
    buffer_load_dwordx2 v[246:247], off, s[36:39], 0 sc1
    s_setprio 2
    s_branch Lckr0
Lck1:
    ds_read_b32 v4, v3 offset:16
    s_waitcnt lgkmcnt(0)
    v_readfirstlane_b32 s59, v4
    s_cmp_eq_u32 s59, 0
    s_cbranch_scc1 Lckr1
    s_mov_b32 s55, 0
    s_setprio 0
    s_lshl_b32 s58, s47, 12
    s_add_u32 s57, s58, 36864
    s_mov_b32 m0, s57
    s_nop 0
    buffer_load_dwordx4 v244, s[40:43], s57 offen offset:0 sc1 lds
    buffer_load_dwordx4 v244, s[40:43], s57 offen offset:1024 sc1 lds
    buffer_load_dwordx4 v244, s[40:43], s57 offen offset:2048 sc1 lds
    buffer_load_dwordx4 v244, s[40:43], s57 offen offset:3072 sc1 lds
    s_add_u32 s57, s58, 53248
    s_mov_b32 m0, s57
    s_nop 0
    buffer_load_dwordx4 v244, s[40:43], s57 offen offset:0 sc1 lds
    buffer_load_dwordx4 v244, s[40:43], s57 offen offset:1024 sc1 lds
    buffer_load_dwordx4 v244, s[40:43], s57 offen offset:2048 sc1 lds
    buffer_load_dwordx4 v244, s[40:43], s57 offen offset:3072 sc1 lds
    s_add_u32 s57, s58, 69632
    s_mov_b32 m0, s57
    s_nop 0
    buffer_load_dwordx4 v244, s[40:43], s57 offen offset:0 sc1 lds
    buffer_load_dwordx4 v244, s[40:43], s57 offen offset:1024 sc1 lds
    buffer_load_dwordx4 v244, s[40:43], s57 offen offset:2048 sc1 lds
    buffer_load_dwordx4 v244, s[40:43], s57 offen offset:3072 sc1 lds
    s_add_u32 s57, s58, 86016
    s_mov_b32 m0, s57
    s_nop 0
    buffer_load_dwordx4 v244, s[40:43], s57 offen offset:0 sc1 lds
    buffer_load_dwordx4 v244, s[40:43], s57 offen offset:1024 sc1 lds
    buffer_load_dwordx4 v244, s[40:43], s57 offen offset:2048 sc1 lds
    buffer_load_dwordx4 v244, s[40:43], s57 offen offset:3072 sc1 lds
    s_add_u32 s57, s58, 102400
    s_mov_b32 m0, s57
    s_nop 0
    buffer_load_dwordx4 v244, s[40:43], s57 offen offset:0 sc1 lds
    buffer_load_dwordx4 v244, s[40:43], s57 offen offset:1024 sc1 lds
    buffer_load_dwordx4 v244, s[40:43], s57 offen offset:2048 sc1 lds
    buffer_load_dwordx4 v244, s[40:43], s57 offen offset:3072 sc1 lds
    s_add_u32 s57, s58, 118784
    s_mov_b32 m0, s57
    s_nop 0
    buffer_load_dwordx4 v244, s[40:43], s57 offen offset:0 sc1 lds
    buffer_load_dwordx4 v244, s[40:43], s57 offen offset:1024 sc1 lds
    buffer_load_dwordx4 v244, s[40:43], s57 offen offset:2048 sc1 lds
    buffer_load_dwordx4 v244, s[40:43], s57 offen offset:3072 sc1 lds
    buffer_load_dwordx2 v[246:247], off, s[36:39], 0 sc1
    s_setprio 2
    s_branch Lckr1
Lck2:
    ds_read_b32 v4, v3 offset:16
    s_waitcnt lgkmcnt(0)
    v_readfirstlane_b32 s59, v4
    s_cmp_eq_u32 s59, 0
    s_cbranch_scc1 Lckr2
    s_mov_b32 s55, 0
    s_setprio 0
    s_lshl_b32 s58, s47, 12
    s_add_u32 s57, s58, 36864
    s_mov_b32 m0, s57
    s_nop 0
    buffer_load_dwordx4 v244, s[40:43], s57 offen offset:0 sc1 lds
    buffer_load_dwordx4 v244, s[40:43], s57 offen offset:1024 sc1 lds
    buffer_load_dwordx4 v244, s[40:43], s57 offen offset:2048 sc1 lds
    buffer_load_dwordx4 v244, s[40:43], s57 offen offset:3072 sc1 lds
    s_add_u32 s57, s58, 53248
    s_mov_b32 m0, s57
    s_nop 0
    buffer_load_dwordx4 v244, s[40:43], s57 offen offset:0 sc1 lds
    buffer_load_dwordx4 v244, s[40:43], s57 offen offset:1024 sc1 lds
    buffer_load_dwordx4 v244, s[40:43], s57 offen offset:2048 sc1 lds
    buffer_load_dwordx4 v244, s[40:43], s57 offen offset:3072 sc1 lds
    s_add_u32 s57, s58, 69632
    s_mov_b32 m0, s57
    s_nop 0
    buffer_load_dwordx4 v244, s[40:43], s57 offen offset:0 sc1 lds
    buffer_load_dwordx4 v244, s[40:43], s57 offen offset:1024 sc1 lds
    buffer_load_dwordx4 v244, s[40:43], s57 offen offset:2048 sc1 lds
    buffer_load_dwordx4 v244, s[40:43], s57 offen offset:3072 sc1 lds
    s_add_u32 s57, s58, 86016
    s_mov_b32 m0, s57
    s_nop 0
    buffer_load_dwordx4 v244, s[40:43], s57 offen offset:0 sc1 lds
    buffer_load_dwordx4 v244, s[40:43], s57 offen offset:1024 sc1 lds
    buffer_load_dwordx4 v244, s[40:43], s57 offen offset:2048 sc1 lds
    buffer_load_dwordx4 v244, s[40:43], s57 offen offset:3072 sc1 lds
    s_add_u32 s57, s58, 102400
    s_mov_b32 m0, s57
    s_nop 0
    buffer_load_dwordx4 v244, s[40:43], s57 offen offset:0 sc1 lds
    buffer_load_dwordx4 v244, s[40:43], s57 offen offset:1024 sc1 lds
    buffer_load_dwordx4 v244, s[40:43], s57 offen offset:2048 sc1 lds
    buffer_load_dwordx4 v244, s[40:43], s57 offen offset:3072 sc1 lds
    s_add_u32 s57, s58, 118784
    s_mov_b32 m0, s57
    s_nop 0
    buffer_load_dwordx4 v244, s[40:43], s57 offen offset:0 sc1 lds
    buffer_load_dwordx4 v244, s[40:43], s57 offen offset:1024 sc1 lds
    buffer_load_dwordx4 v244, s[40:43], s57 offen offset:2048 sc1 lds
    buffer_load_dwordx4 v244, s[40:43], s57 offen offset:3072 sc1 lds
    buffer_load_dwordx2 v[246:247], off, s[36:39], 0 sc1
    s_setprio 2
    s_branch Lckr2
Lkvcu:
    s_add_u32 m0, s53, 4096
    s_add_u32 s57, s48, 128
    buffer_load_dwordx4 v7, s[4:7], s57 offen lds
    buffer_load_dwordx4 v8, s[4:7], s57 offen offset:1024 lds
    s_add_u32 m0, s53, 6144
    s_add_u32 s57, s48, 16512
    buffer_load_dwordx4 v7, s[4:7], s57 offen lds
    buffer_load_dwordx4 v8, s[4:7], s57 offen offset:1024 lds
    s_load_dwordx2 s[32:33], s[0:1], 72
    s_mov_b32 s34, 2097152
    s_mov_b32 s35, 0x20000
    s_load_dwordx2 s[20:21], s[0:1], 32
    s_mov_b32 s22, 524288
    s_mov_b32 s23, 0x20000
    s_load_dwordx2 s[28:29], s[0:1], 64
    s_mov_b32 s30, 1409024
    s_mov_b32 s31, 0x20000
    v_and_b32 v3, 31, v1
    v_lshrrev_b32 v4, 1, v3
    v_and_b32 v4, 7, v4
    v_xor_b32 v4, v4, v2
    v_lshlrev_b32 v3, 7, v3
    v_add_u32 v3, s53, v3
    v_xor_b32 v5, 0, v4
    v_lshl_add_u32 v13, v5, 4, v3
    v_xor_b32 v5, 2, v4
    v_lshl_add_u32 v14, v5, 4, v3
    v_xor_b32 v5, 4, v4
    v_lshl_add_u32 v15, v5, 4, v3
    v_xor_b32 v5, 6, v4
    v_lshl_add_u32 v16, v5, 4, v3
    v_bfe_u32 v3, v1, 2, 2
    v_lshl_add_u32 v3, v2, 3, v3
    v_bfe_u32 v4, v1, 4, 1
    v_and_b32 v5, 3, v1
    v_lshlrev_b32 v5, 3, v5
    v_lshl_add_u32 v6, v4, 5, v5
    v_lshl_add_u32 v18, v3, 6, v6
    v_lshlrev_b32 v4, 14, v4
    v_lshl_add_u32 v17, v3, 5, v5
    s_lshr_b32 s57, s46, 2
    s_lshl_b32 s57, s57, 13
    s_add_u32 s58, s57, 131072
    v_add3_u32 v17, v17, v4, s58
    s_add_u32 s58, s58, s57
    v_add_u32 v18, s58, v18
    v_lshrrev_b32 v3, 2, v1
    v_lshlrev_b32 v3, 10, v3
    v_and_b32 v4, 3, v1
    v_lshl_add_u32 v12, v4, 4, v3
    v_bfe_u32 v3, v1, 4, 1
    v_and_b32 v4, 15, v1
    v_cmp_eq_u32 vcc, v3, v4
    v_mov_b32 v5, 0x3f803f80
    s_nop 0
    v_cndmask_b32 v20, 0, v5, vcc
    v_mov_b32 v21, v20
    v_mov_b32 v22, v20
    v_mov_b32 v23, v20
    v_mov_b32 v24, 0
    v_mov_b32 v25, 0
    v_mov_b32 v26, 0
    v_mov_b32 v27, 0
    s_waitcnt vmcnt(4) lgkmcnt(0)
    s_barrier
    ds_read_b128 v[32:35], v13 offset:0
    ds_read_b64_tr_b16 v[192:193], v17 offset:0
    ds_read_b64_tr_b16 v[194:195], v17 offset:128
    ds_read_b128 v[36:39], v14 offset:0
    ds_read_b64_tr_b16 v[196:197], v17 offset:512
    ds_read_b64_tr_b16 v[198:199], v17 offset:640
    ds_read_b128 v[40:43], v15 offset:0
    ds_read_b64_tr_b16 v[200:201], v17 offset:1024
    ds_read_b64_tr_b16 v[202:203], v17 offset:1152
    ds_read_b128 v[44:47], v16 offset:0
    ds_read_b64_tr_b16 v[204:205], v17 offset:1536
    ds_read_b64_tr_b16 v[206:207], v17 offset:1664
    s_add_u32 m0, s53, 8192
    s_add_u32 s57, s48, 256
    buffer_load_dwordx4 v7, s[4:7], s57 offen lds
    buffer_load_dwordx4 v8, s[4:7], s57 offen offset:1024 lds
    s_add_u32 m0, s53, 10240
    s_add_u32 s57, s48, 16640
    buffer_load_dwordx4 v7, s[4:7], s57 offen lds
    buffer_load_dwordx4 v8, s[4:7], s57 offen offset:1024 lds
    s_add_u32 m0, s53, 12288
    s_add_u32 s57, s48, 384
    buffer_load_dwordx4 v7, s[4:7], s57 offen lds
    buffer_load_dwordx4 v8, s[4:7], s57 offen offset:1024 lds
    s_add_u32 m0, s53, 14336
    s_add_u32 s57, s48, 16768
    buffer_load_dwordx4 v7, s[4:7], s57 offen lds
    buffer_load_dwordx4 v8, s[4:7], s57 offen offset:1024 lds
    v_and_b32 v9, 31, v1
    v_lshlrev_b32 v9, 4, v9
    s_lshl_b32 s57, s44, 2
    s_add_u32 s57, s57, s47
    s_mul_i32 s94, s57, 2080
    s_lshl_b32 s95, s57, 9
    s_add_u32 s95, s95, 8034304
    s_waitcnt lgkmcnt(0)
    v_mfma_f32_32x32x16_bf16 v[112:127], v[192:195], v[32:35], 0
    v_mfma_f32_16x16x32_bf16 v[24:27], v[192:195], v[20:23], v[24:27]
    v_mfma_f32_32x32x16_bf16 v[128:143], v[32:35], v[192:195], 0
    s_waitcnt vmcnt(8)
    v_mfma_f32_32x32x16_bf16 v[112:127], v[196:199], v[36:39], v[112:127]
    ds_read_b128 v[48:51], v13 offset:4096
    ds_read_b64_tr_b16 v[208:209], v17 offset:2048
    v_mfma_f32_16x16x32_bf16 v[24:27], v[196:199], v[20:23], v[24:27]
    ds_read_b64_tr_b16 v[210:211], v17 offset:2176
    ds_read_b128 v[52:55], v14 offset:4096
    v_mfma_f32_32x32x16_bf16 v[128:143], v[36:39], v[196:199], v[128:143]
    ds_read_b64_tr_b16 v[212:213], v17 offset:2560
    ds_read_b64_tr_b16 v[214:215], v17 offset:2688
    v_mfma_f32_32x32x16_bf16 v[112:127], v[200:203], v[40:43], v[112:127]
    ds_read_b128 v[56:59], v15 offset:4096
    ds_read_b64_tr_b16 v[216:217], v17 offset:3072
    v_mfma_f32_16x16x32_bf16 v[24:27], v[200:203], v[20:23], v[24:27]
    ds_read_b64_tr_b16 v[218:219], v17 offset:3200
    ds_read_b128 v[60:63], v16 offset:4096
    v_mfma_f32_32x32x16_bf16 v[128:143], v[40:43], v[200:203], v[128:143]
    ds_read_b64_tr_b16 v[220:221], v17 offset:3584
    ds_read_b64_tr_b16 v[222:223], v17 offset:3712
    v_mfma_f32_32x32x16_bf16 v[112:127], v[204:207], v[44:47], v[112:127]
    v_mfma_f32_16x16x32_bf16 v[24:27], v[204:207], v[20:23], v[24:27]
    v_mfma_f32_32x32x16_bf16 v[128:143], v[44:47], v[204:207], v[128:143]
    s_waitcnt lgkmcnt(0)
    v_mfma_f32_32x32x16_bf16 v[112:127], v[208:211], v[48:51], v[112:127]
    v_mfma_f32_16x16x32_bf16 v[24:27], v[208:211], v[20:23], v[24:27]
    v_mfma_f32_32x32x16_bf16 v[128:143], v[48:51], v[208:211], v[128:143]
    s_waitcnt vmcnt(4)
    v_mfma_f32_32x32x16_bf16 v[112:127], v[212:215], v[52:55], v[112:127]
    ds_read_b128 v[64:67], v13 offset:8192
    ds_read_b64_tr_b16 v[192:193], v17 offset:4096
    v_mfma_f32_16x16x32_bf16 v[24:27], v[212:215], v[20:23], v[24:27]
    ds_read_b64_tr_b16 v[194:195], v17 offset:4224
    ds_read_b128 v[68:71], v14 offset:8192
    v_mfma_f32_32x32x16_bf16 v[128:143], v[52:55], v[212:215], v[128:143]
    ds_read_b64_tr_b16 v[196:197], v17 offset:4608
    ds_read_b64_tr_b16 v[198:199], v17 offset:4736
    v_mfma_f32_32x32x16_bf16 v[112:127], v[216:219], v[56:59], v[112:127]
    ds_read_b128 v[72:75], v15 offset:8192
    ds_read_b64_tr_b16 v[200:201], v17 offset:5120
    v_mfma_f32_16x16x32_bf16 v[24:27], v[216:219], v[20:23], v[24:27]
    ds_read_b64_tr_b16 v[202:203], v17 offset:5248
    ds_read_b128 v[76:79], v16 offset:8192
    v_mfma_f32_32x32x16_bf16 v[128:143], v[56:59], v[216:219], v[128:143]
    ds_read_b64_tr_b16 v[204:205], v17 offset:5632
    ds_read_b64_tr_b16 v[206:207], v17 offset:5760
    v_mfma_f32_32x32x16_bf16 v[112:127], v[220:223], v[60:63], v[112:127]
    v_mfma_f32_16x16x32_bf16 v[24:27], v[220:223], v[20:23], v[24:27]
    v_mfma_f32_32x32x16_bf16 v[128:143], v[60:63], v[220:223], v[128:143]
    s_waitcnt lgkmcnt(0)
    v_mfma_f32_32x32x16_bf16 v[112:127], v[192:195], v[64:67], v[112:127]
    v_mfma_f32_16x16x32_bf16 v[24:27], v[192:195], v[20:23], v[24:27]
    v_mfma_f32_32x32x16_bf16 v[128:143], v[64:67], v[192:195], v[128:143]
    s_waitcnt vmcnt(0)
    v_mfma_f32_32x32x16_bf16 v[112:127], v[196:199], v[68:71], v[112:127]
    ds_read_b128 v[80:83], v13 offset:12288
    ds_read_b64_tr_b16 v[208:209], v17 offset:6144
    v_mfma_f32_16x16x32_bf16 v[24:27], v[196:199], v[20:23], v[24:27]
    ds_read_b64_tr_b16 v[210:211], v17 offset:6272
    ds_read_b128 v[84:87], v14 offset:12288
    v_mfma_f32_32x32x16_bf16 v[128:143], v[68:71], v[196:199], v[128:143]
    ds_read_b64_tr_b16 v[212:213], v17 offset:6656
    ds_read_b64_tr_b16 v[214:215], v17 offset:6784
    v_mfma_f32_32x32x16_bf16 v[112:127], v[200:203], v[72:75], v[112:127]
    ds_read_b128 v[88:91], v15 offset:12288
    ds_read_b64_tr_b16 v[216:217], v17 offset:7168
    v_mfma_f32_16x16x32_bf16 v[24:27], v[200:203], v[20:23], v[24:27]
    ds_read_b64_tr_b16 v[218:219], v17 offset:7296
    ds_read_b128 v[92:95], v16 offset:12288
    v_mfma_f32_32x32x16_bf16 v[128:143], v[72:75], v[200:203], v[128:143]
    ds_read_b64_tr_b16 v[220:221], v17 offset:7680
    ds_read_b64_tr_b16 v[222:223], v17 offset:7808
    v_mfma_f32_32x32x16_bf16 v[112:127], v[204:207], v[76:79], v[112:127]
    v_mfma_f32_16x16x32_bf16 v[24:27], v[204:207], v[20:23], v[24:27]
    v_mfma_f32_32x32x16_bf16 v[128:143], v[76:79], v[204:207], v[128:143]
    s_waitcnt lgkmcnt(0)
    buffer_load_dwordx2 v[246:247], off, s[36:39], 0 sc1
    buffer_load_dwordx4 v[160:163], v9, s[40:43], s95 offen sc1
    v_mfma_f32_32x32x16_bf16 v[112:127], v[208:211], v[80:83], v[112:127]
    v_mfma_f32_16x16x32_bf16 v[24:27], v[208:211], v[20:23], v[24:27]
    v_mfma_f32_32x32x16_bf16 v[128:143], v[80:83], v[208:211], v[128:143]
    v_mfma_f32_32x32x16_bf16 v[112:127], v[212:215], v[84:87], v[112:127]
    v_mfma_f32_16x16x32_bf16 v[24:27], v[212:215], v[20:23], v[24:27]
    v_mfma_f32_32x32x16_bf16 v[128:143], v[84:87], v[212:215], v[128:143]
    v_mfma_f32_32x32x16_bf16 v[112:127], v[216:219], v[88:91], v[112:127]
    v_mfma_f32_16x16x32_bf16 v[24:27], v[216:219], v[20:23], v[24:27]
    v_mfma_f32_32x32x16_bf16 v[128:143], v[88:91], v[216:219], v[128:143]
    v_mfma_f32_32x32x16_bf16 v[112:127], v[220:223], v[92:95], v[112:127]
    v_mfma_f32_16x16x32_bf16 v[24:27], v[220:223], v[20:23], v[24:27]
    v_mfma_f32_32x32x16_bf16 v[128:143], v[92:95], v[220:223], v[128:143]
    v_and_b32 v5, 31, v1
    v_lshlrev_b32 v5, 2, v5
    s_xor_b32 s59, s53, 65536
    s_add_u32 s58, s53, 4352
    s_lshl_b32 s50, s46, 16
    s_add_u32 s50, s50, 960
    s_lshl_b32 s54, s46, 12
    s_add_u32 s54, s54, 131072
    v_and_b32 v3, 1, v1
    v_lshlrev_b32 v3, 6, v3
    v_lshrrev_b32 v4, 4, v1
    v_lshl_add_u32 v3, v4, 4, v3
    v_add_u32 v3, s58, v3
    s_mov_b32 exec_lo, 0x00030003
    s_mov_b32 exec_hi, 0x00030003
    ds_write_b128 v3, v[24:27]
    s_mov_b64 exec, -1
    s_nop 2
    v_add_u32 v3, s53, v244
    v_add_u32 v10, s59, v244
    v_add_u32 v11, s59, v5
    v_lshl_add_u32 v6, v2, 4, s53
    s_cmp_ge_u32 s46, 4
    s_cbranch_scc1 LkvH
    ds_write_b128 v3, v[128:131] offset:0
    ds_write_b128 v3, v[132:135] offset:1024
    ds_write_b128 v3, v[136:139] offset:2048
    ds_write_b128 v3, v[140:143] offset:3072
    v_xor_b32 v4, 0x10000, v6
    s_waitcnt lgkmcnt(0)
    s_barrier
    ds_read_b128 v[192:195], v10
    ds_read_b128 v[196:199], v10 offset:1024
    ds_read_b128 v[172:175], v6 offset:4416
    ds_read_b128 v[176:179], v6 offset:4448
    ds_read_b128 v[200:203], v4 offset:4416
    ds_read_b128 v[204:207], v4 offset:4448
    s_nop 2
    v_and_b32 v3, 0x33, v1
    v_bfe_u32 v4, v1, 2, 1
    v_lshl_or_b32 v3, v4, 3, v3
    v_bfe_u32 v4, v1, 3, 1
    v_lshl_or_b32 v3, v4, 2, v3
    v_lshlrev_b32 v3, 4, v3
    s_waitcnt lgkmcnt(0)
    v_pk_add_f32 v[120:121], v[120:121], v[192:193]
    v_pk_add_f32 v[172:173], v[172:173], v[200:201]
    v_pk_add_f32 v[122:123], v[122:123], v[194:195]
    v_pk_add_f32 v[174:175], v[174:175], v[202:203]
    v_pk_add_f32 v[124:125], v[124:125], v[196:197]
    v_pk_add_f32 v[176:177], v[176:177], v[204:205]
    v_pk_add_f32 v[126:127], v[126:127], v[198:199]
    v_pk_add_f32 v[178:179], v[178:179], v[206:207]
    s_mov_b32 s57, 0
    s_waitcnt vmcnt(0)
Ltag_kl:
    v_readfirstlane_b32 s86, v246
    v_readfirstlane_b32 s87, v247
    s_add_u32 s57, s57, 1
    s_cmp_lg_u32 s86, 0
    s_cbranch_scc1 Ltagd_kl
    s_cmp_ge_u32 s57, 100000
    s_cbranch_scc1 Ltagd_kl
Ltagr_kl:
    s_sleep 1
    buffer_load_dwordx2 v[246:247], off, s[36:39], 0 sc1
    s_waitcnt vmcnt(0)
    s_branch Ltag_kl
Ltagd_kl:
    s_mov_b32 s57, 0
Lks_l:
    v_cmp_ne_u64 vcc, s[86:87], v[162:163]
    s_add_u32 s57, s57, 1
    s_cmp_ge_u32 s57, 100000
    s_cbranch_vccz Lksd_l
    s_cbranch_scc1 Lksd_l
    buffer_load_dwordx4 v[160:163], v9, s[40:43], s95 offen sc1
    s_waitcnt vmcnt(0)
    s_branch Lks_l
Lksd_l:
    v_sub_f32 v164, 0, v160
    v_fma_f32 v120, v164, v172, v120
    v_fma_f32 v121, v164, v173, v121
    v_fma_f32 v122, v164, v174, v122
    v_fma_f32 v123, v164, v175, v123
    v_fma_f32 v124, v164, v176, v124
    v_fma_f32 v125, v164, v177, v125
    v_fma_f32 v126, v164, v178, v126
    v_fma_f32 v127, v164, v179, v127
    v_mul_f32 v120, v120, v161
    v_mul_f32 v121, v121, v161
    v_mul_f32 v122, v122, v161
    v_mul_f32 v123, v123, v161
    v_mul_f32 v124, v124, v161
    v_mul_f32 v125, v125, v161
    v_mul_f32 v126, v126, v161
    v_mul_f32 v127, v127, v161
    v_cvt_pk_bf16_f32 v112, v120, v121
    v_cvt_pk_bf16_f32 v113, v122, v123
    v_cvt_pk_bf16_f32 v114, v124, v125
    v_cvt_pk_bf16_f32 v115, v126, v127
    buffer_store_dwordx4 v[112:115], v3, s[40:43], s94 offen sc1
    s_branch LkvS
LkvH:
    ds_write_b128 v3, v[120:123]
    ds_write_b128 v3, v[124:127] offset:1024
    v_add_u32 v4, s53, v5
    s_waitcnt lgkmcnt(0)
    s_barrier
    ds_read_b32 v166, v4 offset:4352
    ds_read_b32 v167, v11 offset:4352
    ds_read_b128 v[144:147], v10 offset:0
    ds_read_b128 v[148:151], v10 offset:1024
    ds_read_b128 v[152:155], v10 offset:2048
    ds_read_b128 v[156:159], v10 offset:3072
    s_mov_b32 s57, 0
    s_waitcnt vmcnt(0)
Ltag_kh:
    v_readfirstlane_b32 s86, v246
    v_readfirstlane_b32 s87, v247
    s_add_u32 s57, s57, 1
    s_cmp_lg_u32 s86, 0
    s_cbranch_scc1 Ltagd_kh
    s_cmp_ge_u32 s57, 100000
    s_cbranch_scc1 Ltagd_kh
Ltagr_kh:
    s_sleep 1
    buffer_load_dwordx2 v[246:247], off, s[36:39], 0 sc1
    s_waitcnt vmcnt(0)
    s_branch Ltag_kh
Ltagd_kh:
    s_mov_b32 s57, 0
Lks_h:
    v_cmp_ne_u64 vcc, s[86:87], v[162:163]
    s_add_u32 s57, s57, 1
    s_cmp_ge_u32 s57, 100000
    s_cbranch_vccz Lksd_h
    s_cbranch_scc1 Lksd_h
    buffer_load_dwordx4 v[160:163], v9, s[40:43], s95 offen sc1
    s_waitcnt vmcnt(0)
    s_branch Lks_h
Lksd_h:
    ds_write_b32 v4, v160 offset:4608
    ds_write_b32 v4, v161 offset:4736
    s_waitcnt lgkmcnt(0)
    ds_read_b128 v[192:195], v6 offset:4608
    ds_read_b128 v[208:211], v6 offset:4736
    ds_read_b128 v[196:199], v6 offset:4640
    ds_read_b128 v[212:215], v6 offset:4768
    ds_read_b128 v[200:203], v6 offset:4672
    ds_read_b128 v[216:219], v6 offset:4800
    ds_read_b128 v[204:207], v6 offset:4704
    ds_read_b128 v[220:223], v6 offset:4832
    v_add_f32 v166, v166, v167
    v_sub_f32 v166, 0, v166
    v_pk_add_f32 v[128:129], v[128:129], v[144:145]
    v_pk_add_f32 v[130:131], v[130:131], v[146:147]
    v_pk_add_f32 v[132:133], v[132:133], v[148:149]
    v_pk_add_f32 v[134:135], v[134:135], v[150:151]
    v_pk_add_f32 v[136:137], v[136:137], v[152:153]
    v_pk_add_f32 v[138:139], v[138:139], v[154:155]
    v_pk_add_f32 v[140:141], v[140:141], v[156:157]
    v_pk_add_f32 v[142:143], v[142:143], v[158:159]
    s_waitcnt lgkmcnt(0)
    v_fma_f32 v128, v192, v166, v128
    v_fma_f32 v129, v193, v166, v129
    v_fma_f32 v130, v194, v166, v130
    v_fma_f32 v131, v195, v166, v131
    v_fma_f32 v132, v196, v166, v132
    v_fma_f32 v133, v197, v166, v133
    v_fma_f32 v134, v198, v166, v134
    v_fma_f32 v135, v199, v166, v135
    v_fma_f32 v136, v200, v166, v136
    v_fma_f32 v137, v201, v166, v137
    v_fma_f32 v138, v202, v166, v138
    v_fma_f32 v139, v203, v166, v139
    v_fma_f32 v140, v204, v166, v140
    v_fma_f32 v141, v205, v166, v141
    v_fma_f32 v142, v206, v166, v142
    v_fma_f32 v143, v207, v166, v143
    v_pk_mul_f32 v[128:129], v[128:129], v[208:209]
    v_pk_mul_f32 v[130:131], v[130:131], v[210:211]
    v_pk_mul_f32 v[132:133], v[132:133], v[212:213]
    v_pk_mul_f32 v[134:135], v[134:135], v[214:215]
    v_pk_mul_f32 v[136:137], v[136:137], v[216:217]
    v_pk_mul_f32 v[138:139], v[138:139], v[218:219]
    v_pk_mul_f32 v[140:141], v[140:141], v[220:221]
    v_pk_mul_f32 v[142:143], v[142:143], v[222:223]
    v_cvt_pk_bf16_f32 v128, v128, v129
    v_cvt_pk_bf16_f32 v129, v130, v131
    v_cvt_pk_bf16_f32 v130, v132, v133
    v_cvt_pk_bf16_f32 v131, v134, v135
    v_cvt_pk_bf16_f32 v132, v136, v137
    v_cvt_pk_bf16_f32 v133, v138, v139
    v_cvt_pk_bf16_f32 v134, v140, v141
    v_cvt_pk_bf16_f32 v135, v142, v143
    v_and_b32 v3, 15, v1
    v_lshlrev_b32 v3, 4, v3
    v_lshl_add_u32 v3, v2, 8, v3
    s_mov_b32 exec_lo, 0xffff0000
    s_mov_b32 exec_hi, 0xffff0000
    v_mov_b32 v3, 512
    v_mov_b32 v128, 0x3f803f80
    v_mov_b32 v129, 0x3f803f80
    v_mov_b32 v130, 0x3f803f80
    v_mov_b32 v131, 0x3f803f80
    v_mov_b32 v132, 0x3f803f80
    v_mov_b32 v133, 0x3f803f80
    v_mov_b32 v134, 0x3f803f80
    v_mov_b32 v135, 0x3f803f80
    s_mov_b32 exec_lo, 0x1ffff
    s_mov_b32 exec_hi, 0xffff
    buffer_store_dwordx4 v[128:131], v3, s[40:43], s94 offen offset:1024 sc1
    buffer_store_dwordx4 v[132:135], v3, s[40:43], s94 offen offset:1552 sc1
    s_mov_b64 exec, -1
LkvS:
    v_mov_b32 v24, 0
    v_mov_b32 v25, 0
    v_mov_b32 v26, 0
    v_mov_b32 v27, 0
    s_lshl_b32 s59, s44, 7
    s_add_u32 s59, s59, 8032256
    s_waitcnt vmcnt(0)
    s_barrier
    s_cmp_lg_u32 s46, 0
    s_cbranch_scc1 Lsig_kv
    v_mov_b32 v246, s86
    v_mov_b32 v247, s87
    s_mov_b64 exec, 1
    buffer_store_dwordx2 v[246:247], off, s[40:43], s59 sc1
    s_mov_b64 exec, -1
Lsig_kv:
    s_add_u32 m0, s54, 0
    s_add_u32 s57, s50, 0
    buffer_load_dwordx4 v12, s[8:11], s57 offen lds
    s_add_u32 m0, s54, 1024
    s_add_u32 s57, s50, 16384
    buffer_load_dwordx4 v12, s[8:11], s57 offen lds
    s_add_u32 m0, s54, 2048
    s_add_u32 s57, s50, 32768
    buffer_load_dwordx4 v12, s[8:11], s57 offen lds
    s_add_u32 m0, s54, 3072
    s_add_u32 s57, s50, 49152
    buffer_load_dwordx4 v12, s[8:11], s57 offen lds
    s_waitcnt vmcnt(0)
    s_barrier
    ds_read_b64_tr_b16 v[192:193], v18 offset:0
    ds_read_b64_tr_b16 v[194:195], v18 offset:256
    ds_read_b64_tr_b16 v[196:197], v18 offset:1024
    ds_read_b64_tr_b16 v[198:199], v18 offset:1280
    ds_read_b64_tr_b16 v[200:201], v18 offset:2048
    ds_read_b64_tr_b16 v[202:203], v18 offset:2304
    ds_read_b64_tr_b16 v[204:205], v18 offset:3072
    ds_read_b64_tr_b16 v[206:207], v18 offset:3328
    s_waitcnt lgkmcnt(0)
    v_mfma_f32_32x32x16_bf16 v[96:111], v[192:195], v[32:35], 0
    ds_read_b64_tr_b16 v[208:209], v18 offset:4096
    ds_read_b64_tr_b16 v[210:211], v18 offset:4352
    v_mfma_f32_16x16x32_bf16 v[24:27], v[192:195], v[20:23], v[24:27]
    ds_read_b64_tr_b16 v[212:213], v18 offset:5120
    ds_read_b64_tr_b16 v[214:215], v18 offset:5376
    v_mfma_f32_32x32x16_bf16 v[96:111], v[196:199], v[36:39], v[96:111]
    ds_read_b64_tr_b16 v[216:217], v18 offset:6144
    ds_read_b64_tr_b16 v[218:219], v18 offset:6400
    v_mfma_f32_16x16x32_bf16 v[24:27], v[196:199], v[20:23], v[24:27]
    ds_read_b64_tr_b16 v[220:221], v18 offset:7168
    ds_read_b64_tr_b16 v[222:223], v18 offset:7424
    v_mfma_f32_32x32x16_bf16 v[96:111], v[200:203], v[40:43], v[96:111]
    v_mfma_f32_16x16x32_bf16 v[24:27], v[200:203], v[20:23], v[24:27]
    v_mfma_f32_32x32x16_bf16 v[96:111], v[204:207], v[44:47], v[96:111]
    v_mfma_f32_16x16x32_bf16 v[24:27], v[204:207], v[20:23], v[24:27]
    s_waitcnt lgkmcnt(0)
    v_mfma_f32_32x32x16_bf16 v[96:111], v[208:211], v[48:51], v[96:111]
    ds_read_b64_tr_b16 v[192:193], v18 offset:8192
    ds_read_b64_tr_b16 v[194:195], v18 offset:8448
    v_mfma_f32_16x16x32_bf16 v[24:27], v[208:211], v[20:23], v[24:27]
    ds_read_b64_tr_b16 v[196:197], v18 offset:9216
    ds_read_b64_tr_b16 v[198:199], v18 offset:9472
    v_mfma_f32_32x32x16_bf16 v[96:111], v[212:215], v[52:55], v[96:111]
    ds_read_b64_tr_b16 v[200:201], v18 offset:10240
    ds_read_b64_tr_b16 v[202:203], v18 offset:10496
    v_mfma_f32_16x16x32_bf16 v[24:27], v[212:215], v[20:23], v[24:27]
    ds_read_b64_tr_b16 v[204:205], v18 offset:11264
    ds_read_b64_tr_b16 v[206:207], v18 offset:11520
    v_mfma_f32_32x32x16_bf16 v[96:111], v[216:219], v[56:59], v[96:111]
    v_mfma_f32_16x16x32_bf16 v[24:27], v[216:219], v[20:23], v[24:27]
    v_mfma_f32_32x32x16_bf16 v[96:111], v[220:223], v[60:63], v[96:111]
    v_mfma_f32_16x16x32_bf16 v[24:27], v[220:223], v[20:23], v[24:27]
    s_waitcnt lgkmcnt(0)
    v_mfma_f32_32x32x16_bf16 v[96:111], v[192:195], v[64:67], v[96:111]
    ds_read_b64_tr_b16 v[208:209], v18 offset:12288
    ds_read_b64_tr_b16 v[210:211], v18 offset:12544
    v_mfma_f32_16x16x32_bf16 v[24:27], v[192:195], v[20:23], v[24:27]
    ds_read_b64_tr_b16 v[212:213], v18 offset:13312
    ds_read_b64_tr_b16 v[214:215], v18 offset:13568
    v_mfma_f32_32x32x16_bf16 v[96:111], v[196:199], v[68:71], v[96:111]
    ds_read_b64_tr_b16 v[216:217], v18 offset:14336
    ds_read_b64_tr_b16 v[218:219], v18 offset:14592
    v_mfma_f32_16x16x32_bf16 v[24:27], v[196:199], v[20:23], v[24:27]
    ds_read_b64_tr_b16 v[220:221], v18 offset:15360
    ds_read_b64_tr_b16 v[222:223], v18 offset:15616
    v_mfma_f32_32x32x16_bf16 v[96:111], v[200:203], v[72:75], v[96:111]
    v_mfma_f32_16x16x32_bf16 v[24:27], v[200:203], v[20:23], v[24:27]
    v_mfma_f32_32x32x16_bf16 v[96:111], v[204:207], v[76:79], v[96:111]
    v_mfma_f32_16x16x32_bf16 v[24:27], v[204:207], v[20:23], v[24:27]
    s_waitcnt lgkmcnt(0)
    v_mfma_f32_32x32x16_bf16 v[96:111], v[208:211], v[80:83], v[96:111]
    v_mfma_f32_16x16x32_bf16 v[24:27], v[208:211], v[20:23], v[24:27]
    v_mfma_f32_32x32x16_bf16 v[96:111], v[212:215], v[84:87], v[96:111]
    v_mfma_f32_16x16x32_bf16 v[24:27], v[212:215], v[20:23], v[24:27]
    v_mfma_f32_32x32x16_bf16 v[96:111], v[216:219], v[88:91], v[96:111]
    v_mfma_f32_16x16x32_bf16 v[24:27], v[216:219], v[20:23], v[24:27]
    v_mfma_f32_32x32x16_bf16 v[96:111], v[220:223], v[92:95], v[96:111]
    v_mfma_f32_16x16x32_bf16 v[24:27], v[220:223], v[20:23], v[24:27]
    s_or_b32 s59, s53, 73728
    s_lshr_b32 s60, s46, 2
    s_lshl_b32 s60, s60, 7
    s_add_u32 s58, s59, s60
    s_add_u32 s58, s58, 4096
    v_add_u32 v10, s59, v244
    v_lshl_add_u32 v6, v2, 4, s59
    s_nop 3
    v_and_b32 v3, 1, v1
    v_lshlrev_b32 v3, 6, v3
    v_lshrrev_b32 v4, 4, v1
    v_lshl_add_u32 v3, v4, 4, v3
    v_add_u32 v3, s58, v3
    s_mov_b32 exec_lo, 0x00030003
    s_mov_b32 exec_hi, 0x00030003
    ds_write_b128 v3, v[24:27]
    s_mov_b64 exec, -1
    s_nop 2
    s_cmp_ge_u32 s46, 4
    s_cbranch_scc1 LkvH2
    s_waitcnt lgkmcnt(0)
    s_barrier
    ds_read_b128 v[192:195], v10 offset:0
    ds_read_b128 v[196:199], v10 offset:1024
    ds_read_b128 v[200:203], v10 offset:2048
    ds_read_b128 v[204:207], v10 offset:3072
    ds_read_b128 v[144:147], v6 offset:4096
    ds_read_b128 v[148:151], v6 offset:4128
    ds_read_b128 v[152:155], v6 offset:4160
    ds_read_b128 v[156:159], v6 offset:4192
    ds_read_b128 v[208:211], v6 offset:4224
    ds_read_b128 v[212:215], v6 offset:4256
    ds_read_b128 v[216:219], v6 offset:4288
    ds_read_b128 v[220:223], v6 offset:4320
    s_waitcnt lgkmcnt(0)
    v_pk_add_f32 v[96:97], v[96:97], v[192:193]
    v_pk_add_f32 v[144:145], v[144:145], v[208:209]
    v_pk_add_f32 v[98:99], v[98:99], v[194:195]
    v_pk_add_f32 v[146:147], v[146:147], v[210:211]
    v_pk_add_f32 v[100:101], v[100:101], v[196:197]
    v_pk_add_f32 v[148:149], v[148:149], v[212:213]
    v_pk_add_f32 v[102:103], v[102:103], v[198:199]
    v_pk_add_f32 v[150:151], v[150:151], v[214:215]
    v_pk_add_f32 v[104:105], v[104:105], v[200:201]
    v_pk_add_f32 v[152:153], v[152:153], v[216:217]
    v_pk_add_f32 v[106:107], v[106:107], v[202:203]
    v_pk_add_f32 v[154:155], v[154:155], v[218:219]
    v_pk_add_f32 v[108:109], v[108:109], v[204:205]
    v_pk_add_f32 v[156:157], v[156:157], v[220:221]
    v_pk_add_f32 v[110:111], v[110:111], v[206:207]
    v_pk_add_f32 v[158:159], v[158:159], v[222:223]
    v_mul_f32 v162, 0x3eb8aa3b, v161
    v_fma_f32 v96, v164, v144, v96
    v_fma_f32 v97, v164, v145, v97
    v_fma_f32 v98, v164, v146, v98
    v_fma_f32 v99, v164, v147, v99
    v_fma_f32 v100, v164, v148, v100
    v_fma_f32 v101, v164, v149, v101
    v_fma_f32 v102, v164, v150, v102
    v_fma_f32 v103, v164, v151, v103
    v_fma_f32 v104, v164, v152, v104
    v_fma_f32 v105, v164, v153, v105
    v_fma_f32 v106, v164, v154, v106
    v_fma_f32 v107, v164, v155, v107
    v_fma_f32 v108, v164, v156, v108
    v_fma_f32 v109, v164, v157, v109
    v_fma_f32 v110, v164, v158, v110
    v_fma_f32 v111, v164, v159, v111
    v_mul_f32 v96, v96, v162
    v_mul_f32 v97, v97, v162
    v_mul_f32 v98, v98, v162
    v_mul_f32 v99, v99, v162
    v_mul_f32 v100, v100, v162
    v_mul_f32 v101, v101, v162
    v_mul_f32 v102, v102, v162
    v_mul_f32 v103, v103, v162
    v_mul_f32 v104, v104, v162
    v_mul_f32 v105, v105, v162
    v_mul_f32 v106, v106, v162
    v_mul_f32 v107, v107, v162
    v_mul_f32 v108, v108, v162
    v_mul_f32 v109, v109, v162
    v_mul_f32 v110, v110, v162
    v_mul_f32 v111, v111, v162
    v_cvt_pk_bf16_f32 v96, v96, v97
    v_cvt_pk_bf16_f32 v97, v98, v99
    v_cvt_pk_bf16_f32 v98, v100, v101
    v_cvt_pk_bf16_f32 v99, v102, v103
    v_cvt_pk_bf16_f32 v100, v104, v105
    v_cvt_pk_bf16_f32 v101, v106, v107
    v_cvt_pk_bf16_f32 v102, v108, v109
    v_cvt_pk_bf16_f32 v103, v110, v111
    s_lshl_b32 s57, s47, 11
    s_add_u32 s57, s57, 135168
    v_lshl_add_u32 v3, v1, 4, s57
    ds_write_b128 v3, v[96:99]
    ds_write_b128 v3, v[100:103] offset:1024
    s_lshl_b32 s57, s44, 2
    s_add_u32 s57, s57, s47
    s_lshl_b32 s57, s57, 5
    s_lshr_b32 s58, s45, 1
    s_add_u32 s57, s57, s58
    s_and_b32 s58, s45, 1
    s_lshl_b32 s58, s58, 4
    s_add_u32 s57, s57, s58
    s_lshl_b32 s57, s57, 10
    s_add_u32 s98, s57, 5902336
    s_add_u32 s99, s98, 8192
    v_and_b32 v242, 15, v1
    v_lshlrev_b32 v242, 4, v242
    v_lshl_add_u32 v242, v2, 8, v242
    s_mov_b32 exec_lo, 0xffff0000
    s_mov_b32 exec_hi, 0xffff0000
    v_mov_b32 v242, 512
    s_mov_b32 exec_lo, 0xffee0000
    s_mov_b32 exec_hi, 0xffee0000
    v_mov_b32 v242, 0x4000000
    s_mov_b64 exec, -1
    v_add_u32 v242, 1024, v242
    v_mov_b32 v241, v244
    v_mov_b32 v240, 0xdddd
    s_lshl_b32 s57, s47, 11
    s_add_u32 s57, s57, 135168
    v_add_u32 v237, s57, v244
    v_mov_b64 v[104:105], 0
    v_mov_b64 v[106:107], 0
    v_mov_b64 v[108:109], 0
    v_mov_b64 v[110:111], 0
    v_mov_b64 v[112:113], 0
    v_mov_b64 v[114:115], 0
    v_mov_b64 v[120:121], 0
    v_mov_b64 v[122:123], 0
    v_mov_b64 v[124:125], 0
    v_mov_b64 v[126:127], 0
    v_mov_b64 v[128:129], 0
    v_mov_b64 v[130:131], 0
    s_lshl_b32 s57, s61, 16
    s_lshl_b32 s58, s62, 7
    s_add_u32 s57, s57, s58
    s_lshl_b32 s58, s47, 14
    s_add_u32 s70, s57, s58
    s_add_u32 s64, s70, 8192
    v_lshrrev_b32 v3, 3, v1
    v_and_b32 v4, 7, v1
    v_lshlrev_b32 v245, 10, v3
    v_lshl_add_u32 v245, v4, 4, v245
    v_bfe_u32 v4, v1, 1, 2
    v_mul_u32_u24 v4, 8512, v4
    v_lshl_add_u32 v3, v3, 4, v4
    v_and_b32 v4, 1, v1
    v_mul_u32_u24 v4, 1056, v4
    s_and_b32 s57, s47, 1
    s_lshl_b32 s57, s57, 8
    v_add3_u32 v3, v3, v4, s57
    s_lshr_b32 s57, s47, 1
    s_mul_i32 s58, s57, 34048
    s_add_u32 s58, s58, 34048
    v_add_u32 v253, s58, v3
    s_mul_i32 s58, s57, 102144
    v_add_u32 v254, s58, v3
    s_waitcnt lgkmcnt(0)
    s_barrier
    s_branch LaR
LkvH2:
    ds_write_b128 v10, v[96:99] offset:0
    ds_write_b128 v10, v[100:103] offset:1024
    ds_write_b128 v10, v[104:107] offset:2048
    ds_write_b128 v10, v[108:111] offset:3072
    s_mov_b32 s85, 8032256
    v_and_b32 v246, 15, v1
    v_lshlrev_b32 v246, 7, v246
    buffer_load_dwordx2 v[246:247], v246, s[40:43], s85 offen sc1
    s_waitcnt lgkmcnt(0)
    s_barrier
    v_lshrrev_b32 v3, 3, v1
    v_lshlrev_b32 v3, 10, v3
    v_and_b32 v4, 7, v1
    v_bfe_u32 v5, v1, 4, 1
    v_lshlrev_b32 v5, 2, v5
    v_xor_b32 v4, v4, v5
    v_lshl_add_u32 v243, v4, 4, v3
    v_add_u32 v255, 7168, v243
    s_lshl_b32 s67, s47, 14
    s_lshl_b32 s58, s62, 7
    s_add_u32 s67, s67, s58
    s_lshl_b32 s68, s47, 11
    s_mul_i32 s66, s61, 176
    s_mul_i32 s57, s47, 22
    s_add_u32 s66, s66, s57
    s_lshl_b32 s66, s66, 10
    s_add_u32 s66, s66, 135168
    s_lshl_b32 s57, s61, 3
    s_add_u32 s57, s57, s47
    s_lshl_b32 s57, s57, 13
    s_add_u32 s71, s57, 5902336
    s_add_u32 s72, s71, 4096
    s_add_u32 s80, s71, 32768
    s_add_u32 s81, s71, 36864
    s_lshr_b32 s69, s61, 1
    s_lshl_b32 s69, s69, 11
    s_add_u32 s69, s69, 7999488
    s_lshl_b32 s73, s44, 4
    s_add_u32 s73, s73, s45
    s_lshl_b32 s73, s73, 7
    s_add_u32 s73, s73, 7999488
    v_bfe_u32 v3, v1, 2, 2
    v_lshl_add_u32 v3, v2, 2, v3
    v_lshlrev_b32 v3, 7, v3
    v_bfe_u32 v4, v1, 4, 1
    v_lshl_add_u32 v3, v4, 5, v3
    v_and_b32 v4, 3, v1
    v_lshl_add_u32 v3, v4, 3, v3
    v_bfe_u32 v4, v1, 3, 1
    v_lshl_add_u32 v3, v4, 6, v3
    v_add_u32 v248, s68, v3
    v_xor_b32 v249, 64, v248
    v_add_u32 v250, 135168, v248
    v_add_u32 v251, 135168, v249
    s_mul_i32 s57, s47, 2112
    v_add_u32 v238, s57, v244
    v_add_u32 v252, 34048, v238
    v_add_u32 v239, 102144, v238
    s_mov_b32 s57, 0
    s_waitcnt vmcnt(0)
Lfw_kv2:
    v_cmp_ne_u64 vcc, s[86:87], v[246:247]
    s_add_u32 s57, s57, 1
    s_cmp_ge_u32 s57, 100000
    s_cbranch_vccz Lfwd_kv2
    s_cbranch_scc1 Lfwd_kv2
    s_sleep 3
    v_and_b32 v246, 15, v1
    v_lshlrev_b32 v246, 7, v246
    buffer_load_dwordx2 v[246:247], v246, s[40:43], s85 offen sc1
    s_waitcnt vmcnt(0)
    s_branch Lfw_kv2
Lfwd_kv2:
    s_mul_i32 s58, s47, 3072
    s_add_u32 s57, s58, 0
    s_mov_b32 m0, s57
    s_nop 0
    buffer_load_dwordx4 v244, s[40:43], s57 offen offset:0 sc1 lds
    buffer_load_dwordx4 v244, s[40:43], s57 offen offset:1024 sc1 lds
    buffer_load_dwordx4 v244, s[40:43], s57 offen offset:2048 sc1 lds
    s_add_u32 s57, s58, 12288
    s_mov_b32 m0, s57
    s_nop 0
    buffer_load_dwordx4 v244, s[40:43], s57 offen offset:0 sc1 lds
    buffer_load_dwordx4 v244, s[40:43], s57 offen offset:1024 sc1 lds
    buffer_load_dwordx4 v244, s[40:43], s57 offen offset:2048 sc1 lds
    s_add_u32 s57, s58, 24576
    s_mov_b32 m0, s57
    s_nop 0
    buffer_load_dwordx4 v244, s[40:43], s57 offen offset:0 sc1 lds
    buffer_load_dwordx4 v244, s[40:43], s57 offen offset:1024 sc1 lds
    buffer_load_dwordx4 v244, s[40:43], s57 offen offset:2048 sc1 lds
    s_waitcnt vmcnt(0)
    s_barrier
    s_branch LFkv
Lp2:
    s_setprio 3
    s_cmp_eq_u32 s55, 0
    s_cbranch_scc1 Lkvok
    s_mov_b32 s57, 0
    s_waitcnt vmcnt(0)
Lfw_kv:
    v_cmp_ne_u64 vcc, s[86:87], v[246:247]
    s_add_u32 s57, s57, 1
    s_cmp_ge_u32 s57, 100000
    s_cbranch_vccz Lfwd_kv
    s_cbranch_scc1 Lfwd_kv
    s_sleep 3
    v_and_b32 v246, 15, v1
    v_lshlrev_b32 v246, 7, v246
    buffer_load_dwordx2 v[246:247], v246, s[40:43], s85 offen sc1
    s_waitcnt vmcnt(0)
    s_branch Lfw_kv
Lfwd_kv:
    s_mul_i32 s58, s47, 3072
    s_add_u32 s57, s58, 0
    s_mov_b32 m0, s57
    s_nop 0
    buffer_load_dwordx4 v244, s[40:43], s57 offen offset:0 sc1 lds
    buffer_load_dwordx4 v244, s[40:43], s57 offen offset:1024 sc1 lds
    buffer_load_dwordx4 v244, s[40:43], s57 offen offset:2048 sc1 lds
    s_add_u32 s57, s58, 12288
    s_mov_b32 m0, s57
    s_nop 0
    buffer_load_dwordx4 v244, s[40:43], s57 offen offset:0 sc1 lds
    buffer_load_dwordx4 v244, s[40:43], s57 offen offset:1024 sc1 lds
    buffer_load_dwordx4 v244, s[40:43], s57 offen offset:2048 sc1 lds
    s_add_u32 s57, s58, 24576
    s_mov_b32 m0, s57
    s_nop 0
    buffer_load_dwordx4 v244, s[40:43], s57 offen offset:0 sc1 lds
    buffer_load_dwordx4 v244, s[40:43], s57 offen offset:1024 sc1 lds
    buffer_load_dwordx4 v244, s[40:43], s57 offen offset:2048 sc1 lds
    v_mov_b32 v3, 163776
    ds_write_b32 v3, v31 offset:16
    s_nop 3
Lkvok:
    v_mov_b32 v3, 163776
    s_mov_b32 s57, 0
    s_waitcnt vmcnt(0)
    ds_write_b32 v30, v31
Lkw:
    ds_read_b128 v[40:43], v3
    s_add_u32 s57, s57, 1
    s_waitcnt lgkmcnt(0)
    v_and_b32 v40, v40, v41
    v_and_b32 v42, v42, v43
    v_and_b32 v40, v40, v42
    v_cmp_ne_u32 vcc, 0, v40
    s_cmp_ge_u32 s57, 2000000
    s_cbranch_scc1 LaR
    s_cbranch_vccnz LaR
    s_sleep 1
    s_branch Lkw
LaR:
    ds_read_b128 v[8:11], v237
    ds_read_b128 v[16:19], v241
    ds_read_b128 v[12:15], v237 offset:1024
    ds_read_b128 v[20:23], v241 offset:2080
    ds_read_b128 v[24:27], v242
    ds_read_b128 v[32:35], v242 offset:528
    s_waitcnt lgkmcnt(4)
    v_mfma_f32_32x32x16_bf16 v[40:55], v[16:19], v[8:11], 0
    s_waitcnt lgkmcnt(3)
    v_mfma_f32_32x32x16_bf16 v[56:71], v[16:19], v[12:15], 0
    s_nop 9
    v_max3_f32 v3, v40, v41, v42
    v_max3_f32 v3, v3, v43, v44
    v_max3_f32 v3, v3, v45, v46
    v_max3_f32 v3, v3, v47, v48
    v_max3_f32 v3, v3, v49, v50
    v_max3_f32 v3, v3, v51, v52
    v_max3_f32 v3, v3, v53, v54
    v_max_f32 v3, v3, v55
    v_mov_b32 v4, v3
    v_max3_f32 v5, v56, v57, v58
    v_max3_f32 v5, v5, v59, v60
    v_max3_f32 v5, v5, v61, v62
    v_max3_f32 v5, v5, v63, v64
    v_max3_f32 v5, v5, v65, v66
    v_max3_f32 v5, v5, v67, v68
    v_max3_f32 v5, v5, v69, v70
    v_max_f32 v5, v5, v71
    v_mov_b32 v6, v5
    s_nop 1
    v_permlane32_swap_b32 v3, v4
    v_permlane32_swap_b32 v5, v6
    s_mov_b32 s55, 0
    v_max_f32 v3, v3, v4
    v_max_f32 v5, v5, v6
    v_sub_f32 v72, 0, v3
    v_sub_f32 v73, 0, v3
    v_sub_f32 v88, 0, v5
    v_sub_f32 v89, 0, v5
    v_sub_f32 v40, v40, v3
    v_sub_f32 v41, v41, v3
    v_sub_f32 v42, v42, v3
    v_sub_f32 v43, v43, v3
    v_sub_f32 v44, v44, v3
    v_sub_f32 v45, v45, v3
    v_sub_f32 v46, v46, v3
    v_sub_f32 v47, v47, v3
    v_sub_f32 v48, v48, v3
    v_sub_f32 v49, v49, v3
    v_sub_f32 v50, v50, v3
    v_sub_f32 v51, v51, v3
    v_sub_f32 v52, v52, v3
    v_sub_f32 v53, v53, v3
    v_sub_f32 v54, v54, v3
    v_sub_f32 v55, v55, v3
    v_mov_b64 v[90:91], v[88:89]
    v_mov_b64 v[92:93], v[88:89]
    v_mov_b64 v[94:95], v[88:89]
    v_mov_b64 v[96:97], v[88:89]
    v_mov_b64 v[98:99], v[88:89]
    v_mov_b64 v[100:101], v[88:89]
    v_mov_b64 v[102:103], v[88:89]
    v_mov_b64 v[74:75], v[72:73]
    v_mov_b64 v[76:77], v[72:73]
    v_mov_b64 v[78:79], v[72:73]
    v_mov_b64 v[80:81], v[72:73]
    v_mov_b64 v[82:83], v[72:73]
    v_mov_b64 v[84:85], v[72:73]
    v_mov_b64 v[86:87], v[72:73]
    s_setprio 1
    v_exp_f32 v40, v40
    v_exp_f32 v41, v41
    s_branch La1
    .p2align 3
La0:
    v_exp_f32 v40, v40
    v_exp_f32 v41, v41
    v_smfmac_f32_32x32x32_bf16 v[120:135], v[36:39], v[64:71], v240
La1:
    v_exp_f32 v42, v42
    v_exp_f32 v43, v43
    v_exp_f32 v44, v44
    v_mfma_f32_32x32x16_bf16 v[56:71], v[16:19], v[12:15], v[88:103]
    s_waitcnt lgkmcnt(0)
    v_exp_f32 v45, v45
    v_exp_f32 v46, v46
    v_exp_f32 v47, v47
    v_exp_f32 v48, v48
    v_exp_f32 v49, v49
    v_smfmac_f32_32x32x32_bf16 v[104:119], v[24:27], v[40:47], v240
    v_exp_f32 v50, v50
    v_exp_f32 v51, v51
    v_exp_f32 v52, v52
    v_exp_f32 v53, v53
    v_exp_f32 v54, v54
    v_exp_f32 v55, v55
    v_exp_f32 v56, v56
    v_exp_f32 v57, v57
    v_smfmac_f32_32x32x32_bf16 v[104:119], v[32:35], v[48:55], v240
    v_exp_f32 v58, v58
    v_exp_f32 v59, v59
    v_exp_f32 v60, v60
    v_mfma_f32_32x32x16_bf16 v[40:55], v[20:23], v[8:11], v[72:87]
    ds_read_b128 v[28:31], v242 offset:2080
    ds_read_b128 v[36:39], v242 offset:2608
    ds_read_b128 v[16:19], v241 offset:4160
    v_exp_f32 v61, v61
    v_exp_f32 v62, v62
    v_exp_f32 v63, v63
    v_exp_f32 v64, v64
    v_exp_f32 v65, v65
    v_smfmac_f32_32x32x32_bf16 v[120:135], v[24:27], v[56:63], v240
    v_exp_f32 v66, v66
    v_exp_f32 v67, v67
    v_exp_f32 v68, v68
    v_exp_f32 v69, v69
    v_exp_f32 v70, v70
    v_exp_f32 v71, v71
    v_exp_f32 v40, v40
    v_exp_f32 v41, v41
    v_smfmac_f32_32x32x32_bf16 v[120:135], v[32:35], v[64:71], v240
    v_exp_f32 v42, v42
    v_exp_f32 v43, v43
    v_exp_f32 v44, v44
    v_mfma_f32_32x32x16_bf16 v[56:71], v[20:23], v[12:15], v[88:103]
    s_waitcnt lgkmcnt(0)
    v_exp_f32 v45, v45
    v_exp_f32 v46, v46
    v_exp_f32 v47, v47
    v_exp_f32 v48, v48
    v_exp_f32 v49, v49
    v_smfmac_f32_32x32x32_bf16 v[104:119], v[28:31], v[40:47], v240
    v_exp_f32 v50, v50
    v_exp_f32 v51, v51
    v_exp_f32 v52, v52
    v_exp_f32 v53, v53
    v_exp_f32 v54, v54
    v_exp_f32 v55, v55
    v_exp_f32 v56, v56
    v_exp_f32 v57, v57
    v_smfmac_f32_32x32x32_bf16 v[104:119], v[36:39], v[48:55], v240
    v_exp_f32 v58, v58
    v_exp_f32 v59, v59
    v_exp_f32 v60, v60
    v_mfma_f32_32x32x16_bf16 v[40:55], v[16:19], v[8:11], v[72:87]
    ds_read_b128 v[24:27], v242 offset:4160
    ds_read_b128 v[32:35], v242 offset:4688
    ds_read_b128 v[20:23], v241 offset:6240
    v_exp_f32 v61, v61
    v_exp_f32 v62, v62
    v_exp_f32 v63, v63
    v_exp_f32 v64, v64
    v_exp_f32 v65, v65
    v_smfmac_f32_32x32x32_bf16 v[120:135], v[28:31], v[56:63], v240
    v_exp_f32 v66, v66
    v_exp_f32 v67, v67
    v_exp_f32 v68, v68
    v_exp_f32 v69, v69
    v_exp_f32 v70, v70
    v_exp_f32 v71, v71
    v_exp_f32 v40, v40
    v_exp_f32 v41, v41
    v_smfmac_f32_32x32x32_bf16 v[120:135], v[36:39], v[64:71], v240
    v_exp_f32 v42, v42
    v_exp_f32 v43, v43
    v_exp_f32 v44, v44
    v_mfma_f32_32x32x16_bf16 v[56:71], v[16:19], v[12:15], v[88:103]
    s_waitcnt lgkmcnt(0)
    v_exp_f32 v45, v45
    v_exp_f32 v46, v46
    v_exp_f32 v47, v47
    v_exp_f32 v48, v48
    v_exp_f32 v49, v49
    v_smfmac_f32_32x32x32_bf16 v[104:119], v[24:27], v[40:47], v240
    v_exp_f32 v50, v50
    v_exp_f32 v51, v51
    v_exp_f32 v52, v52
    v_exp_f32 v53, v53
    v_exp_f32 v54, v54
    v_exp_f32 v55, v55
    v_exp_f32 v56, v56
    v_exp_f32 v57, v57
    v_smfmac_f32_32x32x32_bf16 v[104:119], v[32:35], v[48:55], v240
    v_exp_f32 v58, v58
    v_exp_f32 v59, v59
    v_exp_f32 v60, v60
    v_mfma_f32_32x32x16_bf16 v[40:55], v[20:23], v[8:11], v[72:87]
    ds_read_b128 v[28:31], v242 offset:6240
    ds_read_b128 v[36:39], v242 offset:6768
    ds_read_b128 v[16:19], v241 offset:8320
    v_exp_f32 v61, v61
    v_exp_f32 v62, v62
    v_exp_f32 v63, v63
    v_exp_f32 v64, v64
    v_exp_f32 v65, v65
    v_smfmac_f32_32x32x32_bf16 v[120:135], v[24:27], v[56:63], v240
    v_exp_f32 v66, v66
    v_exp_f32 v67, v67
    v_exp_f32 v68, v68
    v_exp_f32 v69, v69
    v_exp_f32 v70, v70
    v_exp_f32 v71, v71
    v_exp_f32 v40, v40
    v_exp_f32 v41, v41
    v_smfmac_f32_32x32x32_bf16 v[120:135], v[32:35], v[64:71], v240
    v_exp_f32 v42, v42
    v_exp_f32 v43, v43
    v_exp_f32 v44, v44
    v_mfma_f32_32x32x16_bf16 v[56:71], v[20:23], v[12:15], v[88:103]
    s_waitcnt lgkmcnt(0)
    v_exp_f32 v45, v45
    v_exp_f32 v46, v46
    v_exp_f32 v47, v47
    v_exp_f32 v48, v48
    v_exp_f32 v49, v49
    v_smfmac_f32_32x32x32_bf16 v[104:119], v[28:31], v[40:47], v240
    v_exp_f32 v50, v50
    v_exp_f32 v51, v51
    v_exp_f32 v52, v52
    v_exp_f32 v53, v53
    v_exp_f32 v54, v54
    v_exp_f32 v55, v55
    v_exp_f32 v56, v56
    v_exp_f32 v57, v57
    v_smfmac_f32_32x32x32_bf16 v[104:119], v[36:39], v[48:55], v240
    v_exp_f32 v58, v58
    v_exp_f32 v59, v59
    v_exp_f32 v60, v60
    v_mfma_f32_32x32x16_bf16 v[40:55], v[16:19], v[8:11], v[72:87]
    ds_read_b128 v[24:27], v242 offset:8320
    ds_read_b128 v[32:35], v242 offset:8848
    ds_read_b128 v[20:23], v241 offset:10400
    v_exp_f32 v61, v61
    v_exp_f32 v62, v62
    v_exp_f32 v63, v63
    v_exp_f32 v64, v64
    v_exp_f32 v65, v65
    v_smfmac_f32_32x32x32_bf16 v[120:135], v[28:31], v[56:63], v240
    v_exp_f32 v66, v66
    v_exp_f32 v67, v67
    v_exp_f32 v68, v68
    v_exp_f32 v69, v69
    v_exp_f32 v70, v70
    v_exp_f32 v71, v71
    v_exp_f32 v40, v40
    v_exp_f32 v41, v41
    v_smfmac_f32_32x32x32_bf16 v[120:135], v[36:39], v[64:71], v240
    v_exp_f32 v42, v42
    v_exp_f32 v43, v43
    v_exp_f32 v44, v44
    v_mfma_f32_32x32x16_bf16 v[56:71], v[16:19], v[12:15], v[88:103]
    s_waitcnt lgkmcnt(0)
    v_exp_f32 v45, v45
    v_exp_f32 v46, v46
    v_exp_f32 v47, v47
    v_exp_f32 v48, v48
    v_exp_f32 v49, v49
    v_smfmac_f32_32x32x32_bf16 v[104:119], v[24:27], v[40:47], v240
    v_exp_f32 v50, v50
    v_exp_f32 v51, v51
    v_exp_f32 v52, v52
    v_exp_f32 v53, v53
    v_exp_f32 v54, v54
    v_exp_f32 v55, v55
    v_exp_f32 v56, v56
    v_exp_f32 v57, v57
    v_smfmac_f32_32x32x32_bf16 v[104:119], v[32:35], v[48:55], v240
    v_exp_f32 v58, v58
    v_exp_f32 v59, v59
    v_exp_f32 v60, v60
    v_mfma_f32_32x32x16_bf16 v[40:55], v[20:23], v[8:11], v[72:87]
    ds_read_b128 v[28:31], v242 offset:10400
    ds_read_b128 v[36:39], v242 offset:10928
    ds_read_b128 v[16:19], v241 offset:12480
    v_exp_f32 v61, v61
    v_exp_f32 v62, v62
    v_exp_f32 v63, v63
    v_exp_f32 v64, v64
    v_exp_f32 v65, v65
    v_smfmac_f32_32x32x32_bf16 v[120:135], v[24:27], v[56:63], v240
    v_exp_f32 v66, v66
    v_exp_f32 v67, v67
    v_exp_f32 v68, v68
    v_exp_f32 v69, v69
    v_exp_f32 v70, v70
    v_exp_f32 v71, v71
    v_exp_f32 v40, v40
    v_exp_f32 v41, v41
    v_smfmac_f32_32x32x32_bf16 v[120:135], v[32:35], v[64:71], v240
    v_exp_f32 v42, v42
    v_exp_f32 v43, v43
    v_exp_f32 v44, v44
    v_mfma_f32_32x32x16_bf16 v[56:71], v[20:23], v[12:15], v[88:103]
    s_waitcnt lgkmcnt(0)
    v_exp_f32 v45, v45
    v_exp_f32 v46, v46
    v_exp_f32 v47, v47
    v_exp_f32 v48, v48
    v_exp_f32 v49, v49
    v_smfmac_f32_32x32x32_bf16 v[104:119], v[28:31], v[40:47], v240
    v_exp_f32 v50, v50
    v_exp_f32 v51, v51
    v_exp_f32 v52, v52
    v_exp_f32 v53, v53
    v_exp_f32 v54, v54
    v_exp_f32 v55, v55
    v_exp_f32 v56, v56
    v_exp_f32 v57, v57
    v_smfmac_f32_32x32x32_bf16 v[104:119], v[36:39], v[48:55], v240
    v_exp_f32 v58, v58
    v_exp_f32 v59, v59
    v_exp_f32 v60, v60
    v_mfma_f32_32x32x16_bf16 v[40:55], v[16:19], v[8:11], v[72:87]
    ds_read_b128 v[24:27], v242 offset:12480
    ds_read_b128 v[32:35], v242 offset:13008
    ds_read_b128 v[20:23], v241 offset:14560
    v_exp_f32 v61, v61
    v_exp_f32 v62, v62
    v_exp_f32 v63, v63
    v_exp_f32 v64, v64
    v_exp_f32 v65, v65
    v_smfmac_f32_32x32x32_bf16 v[120:135], v[28:31], v[56:63], v240
    v_exp_f32 v66, v66
    v_exp_f32 v67, v67
    v_exp_f32 v68, v68
    v_exp_f32 v69, v69
    v_exp_f32 v70, v70
    v_exp_f32 v71, v71
    v_exp_f32 v40, v40
    v_exp_f32 v41, v41
    v_smfmac_f32_32x32x32_bf16 v[120:135], v[36:39], v[64:71], v240
    v_exp_f32 v42, v42
    v_exp_f32 v43, v43
    v_exp_f32 v44, v44
    v_mfma_f32_32x32x16_bf16 v[56:71], v[16:19], v[12:15], v[88:103]
    s_waitcnt lgkmcnt(0)
    v_exp_f32 v45, v45
    v_exp_f32 v46, v46
    v_exp_f32 v47, v47
    v_exp_f32 v48, v48
    v_exp_f32 v49, v49
    v_smfmac_f32_32x32x32_bf16 v[104:119], v[24:27], v[40:47], v240
    v_exp_f32 v50, v50
    v_exp_f32 v51, v51
    v_exp_f32 v52, v52
    v_exp_f32 v53, v53
    v_exp_f32 v54, v54
    v_exp_f32 v55, v55
    v_exp_f32 v56, v56
    v_exp_f32 v57, v57
    v_smfmac_f32_32x32x32_bf16 v[104:119], v[32:35], v[48:55], v240
    v_exp_f32 v58, v58
    v_exp_f32 v59, v59
    v_exp_f32 v60, v60
    v_mfma_f32_32x32x16_bf16 v[40:55], v[20:23], v[8:11], v[72:87]
    ds_read_b128 v[28:31], v242 offset:14560
    ds_read_b128 v[36:39], v242 offset:15088
    ds_read_b128 v[16:19], v241 offset:16640
    v_exp_f32 v61, v61
    v_exp_f32 v62, v62
    v_exp_f32 v63, v63
    v_exp_f32 v64, v64
    v_exp_f32 v65, v65
    v_smfmac_f32_32x32x32_bf16 v[120:135], v[24:27], v[56:63], v240
    v_exp_f32 v66, v66
    v_exp_f32 v67, v67
    v_exp_f32 v68, v68
    v_exp_f32 v69, v69
    v_exp_f32 v70, v70
    v_exp_f32 v71, v71
    v_exp_f32 v40, v40
    v_exp_f32 v41, v41
    v_smfmac_f32_32x32x32_bf16 v[120:135], v[32:35], v[64:71], v240
    v_exp_f32 v42, v42
    v_exp_f32 v43, v43
    v_exp_f32 v44, v44
    v_mfma_f32_32x32x16_bf16 v[56:71], v[20:23], v[12:15], v[88:103]
    s_waitcnt lgkmcnt(0)
    v_exp_f32 v45, v45
    v_exp_f32 v46, v46
    v_exp_f32 v47, v47
    v_exp_f32 v48, v48
    v_exp_f32 v49, v49
    v_smfmac_f32_32x32x32_bf16 v[104:119], v[28:31], v[40:47], v240
    v_exp_f32 v50, v50
    v_exp_f32 v51, v51
    v_exp_f32 v52, v52
    v_exp_f32 v53, v53
    v_exp_f32 v54, v54
    v_exp_f32 v55, v55
    v_exp_f32 v56, v56
    v_exp_f32 v57, v57
    v_smfmac_f32_32x32x32_bf16 v[104:119], v[36:39], v[48:55], v240
    v_exp_f32 v58, v58
    v_exp_f32 v59, v59
    v_exp_f32 v60, v60
    v_mfma_f32_32x32x16_bf16 v[40:55], v[16:19], v[8:11], v[72:87]
    ds_read_b128 v[24:27], v242 offset:16640
    ds_read_b128 v[32:35], v242 offset:17168
    ds_read_b128 v[20:23], v241 offset:18720
    v_exp_f32 v61, v61
    v_exp_f32 v62, v62
    v_exp_f32 v63, v63
    v_exp_f32 v64, v64
    v_exp_f32 v65, v65
    v_smfmac_f32_32x32x32_bf16 v[120:135], v[28:31], v[56:63], v240
    v_exp_f32 v66, v66
    v_exp_f32 v67, v67
    v_exp_f32 v68, v68
    v_exp_f32 v69, v69
    v_exp_f32 v70, v70
    v_exp_f32 v71, v71
    v_exp_f32 v40, v40
    v_exp_f32 v41, v41
    v_smfmac_f32_32x32x32_bf16 v[120:135], v[36:39], v[64:71], v240
    v_exp_f32 v42, v42
    v_exp_f32 v43, v43
    v_exp_f32 v44, v44
    v_mfma_f32_32x32x16_bf16 v[56:71], v[16:19], v[12:15], v[88:103]
    s_waitcnt lgkmcnt(0)
    v_exp_f32 v45, v45
    v_exp_f32 v46, v46
    v_exp_f32 v47, v47
    v_exp_f32 v48, v48
    v_exp_f32 v49, v49
    v_smfmac_f32_32x32x32_bf16 v[104:119], v[24:27], v[40:47], v240
    v_exp_f32 v50, v50
    v_exp_f32 v51, v51
    v_exp_f32 v52, v52
    v_exp_f32 v53, v53
    v_exp_f32 v54, v54
    v_exp_f32 v55, v55
    v_exp_f32 v56, v56
    v_exp_f32 v57, v57
    v_smfmac_f32_32x32x32_bf16 v[104:119], v[32:35], v[48:55], v240
    v_exp_f32 v58, v58
    v_exp_f32 v59, v59
    v_exp_f32 v60, v60
    v_mfma_f32_32x32x16_bf16 v[40:55], v[20:23], v[8:11], v[72:87]
    ds_read_b128 v[28:31], v242 offset:18720
    ds_read_b128 v[36:39], v242 offset:19248
    ds_read_b128 v[16:19], v241 offset:20800
    v_exp_f32 v61, v61
    v_exp_f32 v62, v62
    v_exp_f32 v63, v63
    v_exp_f32 v64, v64
    v_exp_f32 v65, v65
    v_smfmac_f32_32x32x32_bf16 v[120:135], v[24:27], v[56:63], v240
    v_exp_f32 v66, v66
    v_exp_f32 v67, v67
    v_exp_f32 v68, v68
    v_exp_f32 v69, v69
    v_exp_f32 v70, v70
    v_exp_f32 v71, v71
    v_exp_f32 v40, v40
    v_exp_f32 v41, v41
    v_smfmac_f32_32x32x32_bf16 v[120:135], v[32:35], v[64:71], v240
    v_exp_f32 v42, v42
    v_exp_f32 v43, v43
    v_exp_f32 v44, v44
    v_mfma_f32_32x32x16_bf16 v[56:71], v[20:23], v[12:15], v[88:103]
    s_waitcnt lgkmcnt(0)
    v_exp_f32 v45, v45
    v_exp_f32 v46, v46
    v_exp_f32 v47, v47
    v_exp_f32 v48, v48
    v_exp_f32 v49, v49
    v_smfmac_f32_32x32x32_bf16 v[104:119], v[28:31], v[40:47], v240
    v_exp_f32 v50, v50
    v_exp_f32 v51, v51
    v_exp_f32 v52, v52
    v_exp_f32 v53, v53
    v_exp_f32 v54, v54
    v_exp_f32 v55, v55
    v_exp_f32 v56, v56
    v_exp_f32 v57, v57
    v_smfmac_f32_32x32x32_bf16 v[104:119], v[36:39], v[48:55], v240
    v_exp_f32 v58, v58
    v_exp_f32 v59, v59
    v_exp_f32 v60, v60
    v_mfma_f32_32x32x16_bf16 v[40:55], v[16:19], v[8:11], v[72:87]
    ds_read_b128 v[24:27], v242 offset:20800
    ds_read_b128 v[32:35], v242 offset:21328
    ds_read_b128 v[20:23], v241 offset:22880
    v_exp_f32 v61, v61
    v_exp_f32 v62, v62
    v_exp_f32 v63, v63
    v_exp_f32 v64, v64
    v_exp_f32 v65, v65
    v_smfmac_f32_32x32x32_bf16 v[120:135], v[28:31], v[56:63], v240
    v_exp_f32 v66, v66
    v_exp_f32 v67, v67
    v_exp_f32 v68, v68
    v_exp_f32 v69, v69
    v_exp_f32 v70, v70
    v_exp_f32 v71, v71
    v_exp_f32 v40, v40
    v_exp_f32 v41, v41
    v_smfmac_f32_32x32x32_bf16 v[120:135], v[36:39], v[64:71], v240
    v_exp_f32 v42, v42
    v_exp_f32 v43, v43
    v_exp_f32 v44, v44
    v_mfma_f32_32x32x16_bf16 v[56:71], v[16:19], v[12:15], v[88:103]
    s_waitcnt lgkmcnt(0)
    v_exp_f32 v45, v45
    v_exp_f32 v46, v46
    v_exp_f32 v47, v47
    v_exp_f32 v48, v48
    v_exp_f32 v49, v49
    v_smfmac_f32_32x32x32_bf16 v[104:119], v[24:27], v[40:47], v240
    v_exp_f32 v50, v50
    v_exp_f32 v51, v51
    v_exp_f32 v52, v52
    v_exp_f32 v53, v53
    v_exp_f32 v54, v54
    v_exp_f32 v55, v55
    v_exp_f32 v56, v56
    v_exp_f32 v57, v57
    v_smfmac_f32_32x32x32_bf16 v[104:119], v[32:35], v[48:55], v240
    v_exp_f32 v58, v58
    v_exp_f32 v59, v59
    v_exp_f32 v60, v60
    v_mfma_f32_32x32x16_bf16 v[40:55], v[20:23], v[8:11], v[72:87]
    ds_read_b128 v[28:31], v242 offset:22880
    ds_read_b128 v[36:39], v242 offset:23408
    ds_read_b128 v[16:19], v241 offset:24960
    v_exp_f32 v61, v61
    v_exp_f32 v62, v62
    v_exp_f32 v63, v63
    v_exp_f32 v64, v64
    v_exp_f32 v65, v65
    v_smfmac_f32_32x32x32_bf16 v[120:135], v[24:27], v[56:63], v240
    v_exp_f32 v66, v66
    v_exp_f32 v67, v67
    v_exp_f32 v68, v68
    v_exp_f32 v69, v69
    v_exp_f32 v70, v70
    v_exp_f32 v71, v71
    v_exp_f32 v40, v40
    v_exp_f32 v41, v41
    v_smfmac_f32_32x32x32_bf16 v[120:135], v[32:35], v[64:71], v240
    v_exp_f32 v42, v42
    v_exp_f32 v43, v43
    v_exp_f32 v44, v44
    v_mfma_f32_32x32x16_bf16 v[56:71], v[20:23], v[12:15], v[88:103]
    s_waitcnt lgkmcnt(0)
    v_exp_f32 v45, v45
    v_exp_f32 v46, v46
    v_exp_f32 v47, v47
    v_exp_f32 v48, v48
    v_exp_f32 v49, v49
    v_smfmac_f32_32x32x32_bf16 v[104:119], v[28:31], v[40:47], v240
    v_exp_f32 v50, v50
    v_exp_f32 v51, v51
    v_exp_f32 v52, v52
    v_exp_f32 v53, v53
    v_exp_f32 v54, v54
    v_exp_f32 v55, v55
    v_exp_f32 v56, v56
    v_exp_f32 v57, v57
    v_smfmac_f32_32x32x32_bf16 v[104:119], v[36:39], v[48:55], v240
    v_exp_f32 v58, v58
    v_exp_f32 v59, v59
    v_exp_f32 v60, v60
    v_mfma_f32_32x32x16_bf16 v[40:55], v[16:19], v[8:11], v[72:87]
    ds_read_b128 v[24:27], v242 offset:24960
    ds_read_b128 v[32:35], v242 offset:25488
    ds_read_b128 v[20:23], v241 offset:27040
    v_exp_f32 v61, v61
    v_exp_f32 v62, v62
    v_exp_f32 v63, v63
    v_exp_f32 v64, v64
    v_exp_f32 v65, v65
    v_smfmac_f32_32x32x32_bf16 v[120:135], v[28:31], v[56:63], v240
    v_exp_f32 v66, v66
    v_exp_f32 v67, v67
    v_exp_f32 v68, v68
    v_exp_f32 v69, v69
    v_exp_f32 v70, v70
    v_exp_f32 v71, v71
    v_exp_f32 v40, v40
    v_exp_f32 v41, v41
    v_smfmac_f32_32x32x32_bf16 v[120:135], v[36:39], v[64:71], v240
    v_exp_f32 v42, v42
    v_exp_f32 v43, v43
    v_exp_f32 v44, v44
    v_mfma_f32_32x32x16_bf16 v[56:71], v[16:19], v[12:15], v[88:103]
    s_waitcnt lgkmcnt(0)
    v_exp_f32 v45, v45
    v_exp_f32 v46, v46
    v_exp_f32 v47, v47
    v_exp_f32 v48, v48
    v_exp_f32 v49, v49
    v_smfmac_f32_32x32x32_bf16 v[104:119], v[24:27], v[40:47], v240
    v_exp_f32 v50, v50
    v_exp_f32 v51, v51
    v_exp_f32 v52, v52
    v_exp_f32 v53, v53
    v_exp_f32 v54, v54
    v_exp_f32 v55, v55
    v_exp_f32 v56, v56
    v_exp_f32 v57, v57
    v_smfmac_f32_32x32x32_bf16 v[104:119], v[32:35], v[48:55], v240
    v_exp_f32 v58, v58
    v_exp_f32 v59, v59
    v_exp_f32 v60, v60
    v_mfma_f32_32x32x16_bf16 v[40:55], v[20:23], v[8:11], v[72:87]
    ds_read_b128 v[28:31], v242 offset:27040
    ds_read_b128 v[36:39], v242 offset:27568
    ds_read_b128 v[16:19], v241 offset:29120
    v_exp_f32 v61, v61
    v_exp_f32 v62, v62
    v_exp_f32 v63, v63
    v_exp_f32 v64, v64
    v_exp_f32 v65, v65
    v_smfmac_f32_32x32x32_bf16 v[120:135], v[24:27], v[56:63], v240
    v_exp_f32 v66, v66
    v_exp_f32 v67, v67
    v_exp_f32 v68, v68
    v_exp_f32 v69, v69
    v_exp_f32 v70, v70
    v_exp_f32 v71, v71
    v_exp_f32 v40, v40
    v_exp_f32 v41, v41
    v_smfmac_f32_32x32x32_bf16 v[120:135], v[32:35], v[64:71], v240
    v_exp_f32 v42, v42
    v_exp_f32 v43, v43
    v_exp_f32 v44, v44
    v_mfma_f32_32x32x16_bf16 v[56:71], v[20:23], v[12:15], v[88:103]
    s_waitcnt lgkmcnt(0)
    v_exp_f32 v45, v45
    v_exp_f32 v46, v46
    v_exp_f32 v47, v47
    v_exp_f32 v48, v48
    v_exp_f32 v49, v49
    v_smfmac_f32_32x32x32_bf16 v[104:119], v[28:31], v[40:47], v240
    v_exp_f32 v50, v50
    v_exp_f32 v51, v51
    v_exp_f32 v52, v52
    v_exp_f32 v53, v53
    v_exp_f32 v54, v54
    v_exp_f32 v55, v55
    v_exp_f32 v56, v56
    v_exp_f32 v57, v57
    v_smfmac_f32_32x32x32_bf16 v[104:119], v[36:39], v[48:55], v240
    v_exp_f32 v58, v58
    v_exp_f32 v59, v59
    v_exp_f32 v60, v60
    v_mfma_f32_32x32x16_bf16 v[40:55], v[16:19], v[8:11], v[72:87]
    ds_read_b128 v[24:27], v242 offset:29120
    ds_read_b128 v[32:35], v242 offset:29648
    ds_read_b128 v[20:23], v241 offset:31200
    v_exp_f32 v61, v61
    v_exp_f32 v62, v62
    v_exp_f32 v63, v63
    v_exp_f32 v64, v64
    v_exp_f32 v65, v65
    v_smfmac_f32_32x32x32_bf16 v[120:135], v[28:31], v[56:63], v240
    v_exp_f32 v66, v66
    v_exp_f32 v67, v67
    v_exp_f32 v68, v68
    v_exp_f32 v69, v69
    v_exp_f32 v70, v70
    v_exp_f32 v71, v71
    v_exp_f32 v40, v40
    v_exp_f32 v41, v41
    v_smfmac_f32_32x32x32_bf16 v[120:135], v[36:39], v[64:71], v240
    v_exp_f32 v42, v42
    v_exp_f32 v43, v43
    v_exp_f32 v44, v44
    v_mfma_f32_32x32x16_bf16 v[56:71], v[16:19], v[12:15], v[88:103]
    s_waitcnt lgkmcnt(0)
    v_exp_f32 v45, v45
    v_exp_f32 v46, v46
    v_exp_f32 v47, v47
    v_exp_f32 v48, v48
    v_exp_f32 v49, v49
    v_smfmac_f32_32x32x32_bf16 v[104:119], v[24:27], v[40:47], v240
    v_exp_f32 v50, v50
    v_exp_f32 v51, v51
    v_exp_f32 v52, v52
    v_exp_f32 v53, v53
    v_exp_f32 v54, v54
    v_exp_f32 v55, v55
    v_exp_f32 v56, v56
    v_exp_f32 v57, v57
    v_smfmac_f32_32x32x32_bf16 v[104:119], v[32:35], v[48:55], v240
    v_exp_f32 v58, v58
    v_exp_f32 v59, v59
    v_exp_f32 v60, v60
    v_mfma_f32_32x32x16_bf16 v[40:55], v[20:23], v[8:11], v[72:87]
    ds_read_b128 v[28:31], v242 offset:31200
    ds_read_b128 v[36:39], v242 offset:31728
    ds_read_b128 v[16:19], v241 offset:33280
    v_exp_f32 v61, v61
    v_exp_f32 v62, v62
    v_exp_f32 v63, v63
    v_exp_f32 v64, v64
    v_exp_f32 v65, v65
    v_smfmac_f32_32x32x32_bf16 v[120:135], v[24:27], v[56:63], v240
    v_exp_f32 v66, v66
    v_exp_f32 v67, v67
    v_exp_f32 v68, v68
    v_exp_f32 v69, v69
    v_exp_f32 v70, v70
    v_exp_f32 v71, v71
    v_exp_f32 v40, v40
    v_exp_f32 v41, v41
    v_smfmac_f32_32x32x32_bf16 v[120:135], v[32:35], v[64:71], v240
    v_exp_f32 v42, v42
    v_exp_f32 v43, v43
    v_exp_f32 v44, v44
    v_mfma_f32_32x32x16_bf16 v[56:71], v[20:23], v[12:15], v[88:103]
    s_waitcnt lgkmcnt(0)
    v_exp_f32 v45, v45
    v_exp_f32 v46, v46
    v_exp_f32 v47, v47
    v_exp_f32 v48, v48
    v_exp_f32 v49, v49
    v_smfmac_f32_32x32x32_bf16 v[104:119], v[28:31], v[40:47], v240
    v_exp_f32 v50, v50
    v_exp_f32 v51, v51
    v_exp_f32 v52, v52
    v_exp_f32 v53, v53
    v_exp_f32 v54, v54
    v_exp_f32 v55, v55
    v_exp_f32 v56, v56
    v_exp_f32 v57, v57
    v_smfmac_f32_32x32x32_bf16 v[104:119], v[36:39], v[48:55], v240
    v_exp_f32 v58, v58
    v_exp_f32 v59, v59
    v_exp_f32 v60, v60
    v_mfma_f32_32x32x16_bf16 v[40:55], v[16:19], v[8:11], v[72:87]
    ds_read_b128 v[24:27], v242 offset:33280
    ds_read_b128 v[32:35], v242 offset:33808
    ds_read_b128 v[20:23], v241 offset:35360
    v_exp_f32 v61, v61
    v_exp_f32 v62, v62
    v_exp_f32 v63, v63
    v_exp_f32 v64, v64
    v_exp_f32 v65, v65
    v_smfmac_f32_32x32x32_bf16 v[120:135], v[28:31], v[56:63], v240
    v_exp_f32 v66, v66
    v_exp_f32 v67, v67
    v_exp_f32 v68, v68
    v_exp_f32 v69, v69
    v_exp_f32 v70, v70
    v_exp_f32 v71, v71
    v_add_u32 v241, 33280, v241
    v_add_u32 v242, 33280, v242
    s_add_u32 s55, s55, 1
    s_cmp_eq_u32 s55, 1
    s_cbranch_scc0 La2
    s_waitcnt vmcnt(0)
    s_barrier
    s_branch La0
La2:
    s_cmp_lt_u32 s55, 4
    s_cbranch_scc1 La0
    v_smfmac_f32_32x32x32_bf16 v[120:135], v[36:39], v[64:71], v240
    s_mov_b32 s94, 0x53800000
    s_mov_b32 s95, 0x7e800000
    s_mov_b32 s63, 0
Lfin0:
    v_rcp_f32 v114, v112
    v_max3_f32 v4, abs(v104), abs(v105), abs(v106)
    v_max3_f32 v4, v4, abs(v107), abs(v108)
    v_max3_f32 v4, v4, abs(v109), abs(v110)
    v_max_f32 v4, v4, abs(v111)
    v_cmp_nlt_f32 vcc, v112, s94
    v_cmp_nlt_f32 s[88:89], v4, s95
    v_mul_f32 v104, v104, v114
    v_mul_f32 v105, v105, v114
    v_mul_f32 v106, v106, v114
    v_mul_f32 v107, v107, v114
    v_mul_f32 v108, v108, v114
    v_mul_f32 v109, v109, v114
    v_mul_f32 v110, v110, v114
    v_mul_f32 v111, v111, v114
    s_or_b64 vcc, vcc, s[88:89]
    v_cvt_pk_bf16_f32 v104, v104, v105
    v_cvt_pk_bf16_f32 v105, v106, v107
    v_cvt_pk_bf16_f32 v106, v108, v109
    v_cvt_pk_bf16_f32 v107, v110, v111
    v_min_u32 v104, -2, v104
    v_min_u32 v105, -2, v105
    v_min_u32 v106, -2, v106
    v_min_u32 v107, -2, v107
    s_cbranch_vccnz Lfallback0
Lok0:
    buffer_store_dwordx4 v[104:107], v244, s[40:43], s98 offen sc1
    s_mov_b32 s63, 0
Lfin1:
    v_rcp_f32 v130, v128
    v_max3_f32 v4, abs(v120), abs(v121), abs(v122)
    v_max3_f32 v4, v4, abs(v123), abs(v124)
    v_max3_f32 v4, v4, abs(v125), abs(v126)
    v_max_f32 v4, v4, abs(v127)
    v_cmp_nlt_f32 vcc, v128, s94
    v_cmp_nlt_f32 s[88:89], v4, s95
    v_mul_f32 v120, v120, v130
    v_mul_f32 v121, v121, v130
    v_mul_f32 v122, v122, v130
    v_mul_f32 v123, v123, v130
    v_mul_f32 v124, v124, v130
    v_mul_f32 v125, v125, v130
    v_mul_f32 v126, v126, v130
    v_mul_f32 v127, v127, v130
    s_or_b64 vcc, vcc, s[88:89]
    v_cvt_pk_bf16_f32 v120, v120, v121
    v_cvt_pk_bf16_f32 v121, v122, v123
    v_cvt_pk_bf16_f32 v122, v124, v125
    v_cvt_pk_bf16_f32 v123, v126, v127
    v_min_u32 v120, -2, v120
    v_min_u32 v121, -2, v121
    v_min_u32 v122, -2, v122
    v_min_u32 v123, -2, v123
    s_cbranch_vccnz Lfallback1
Lok1:
    buffer_store_dwordx4 v[120:123], v244, s[40:43], s99 offen sc1
    buffer_load_dwordx4 v[136:139], v245, s[4:7], s70 offen
    buffer_load_dwordx4 v[140:143], v245, s[4:7], s64 offen
    s_waitcnt lgkmcnt(0)
    s_setprio 0
    s_barrier
    s_barrier
    ds_read_b128 v[144:147], v253 offset:0
    ds_read_b128 v[148:151], v253 offset:512
    ds_read_b128 v[152:155], v253 offset:2112
    ds_read_b128 v[156:159], v253 offset:2624
    ds_read_b128 v[160:163], v253 offset:4224
    ds_read_b128 v[164:167], v253 offset:4736
    ds_read_b128 v[168:171], v253 offset:6336
    ds_read_b128 v[172:175], v253 offset:6848
    ds_read_b128 v[176:179], v253 offset:128
    ds_read_b128 v[180:183], v253 offset:640
    ds_read_b128 v[184:187], v253 offset:2240
    ds_read_b128 v[188:191], v253 offset:2752
    ds_read_b128 v[192:195], v253 offset:4352
    ds_read_b128 v[196:199], v253 offset:4864
    ds_read_b128 v[200:203], v253 offset:6464
    ds_read_b128 v[204:207], v253 offset:6976
    s_waitcnt lgkmcnt(8)
    v_add_f32 v144, v144, v152
    v_add_f32 v160, v160, v168
    v_add_f32 v145, v145, v153
    v_add_f32 v161, v161, v169
    v_add_f32 v146, v146, v154
    v_add_f32 v162, v162, v170
    v_add_f32 v147, v147, v155
    v_add_f32 v163, v163, v171
    v_add_f32 v148, v148, v156
    v_add_f32 v164, v164, v172
    v_add_f32 v149, v149, v157
    v_add_f32 v165, v165, v173
    v_add_f32 v150, v150, v158
    v_add_f32 v166, v166, v174
    v_add_f32 v151, v151, v159
    v_add_f32 v167, v167, v175
    v_add_f32 v144, v144, v160
    v_add_f32 v145, v145, v161
    v_add_f32 v146, v146, v162
    v_add_f32 v147, v147, v163
    v_add_f32 v148, v148, v164
    v_add_f32 v149, v149, v165
    v_add_f32 v150, v150, v166
    v_add_f32 v151, v151, v167
    v_mul_f32 v152, 0xbfb8aa3b, v144
    v_mul_f32 v153, 0xbfb8aa3b, v145
    v_mul_f32 v154, 0xbfb8aa3b, v146
    v_mul_f32 v155, 0xbfb8aa3b, v147
    v_mul_f32 v156, 0xbfb8aa3b, v148
    v_mul_f32 v157, 0xbfb8aa3b, v149
    v_mul_f32 v158, 0xbfb8aa3b, v150
    v_mul_f32 v159, 0xbfb8aa3b, v151
    v_exp_f32 v152, v152
    v_exp_f32 v153, v153
    v_exp_f32 v154, v154
    v_exp_f32 v155, v155
    v_exp_f32 v156, v156
    v_exp_f32 v157, v157
    v_exp_f32 v158, v158
    v_exp_f32 v159, v159
    v_add_f32 v152, 1.0, v152
    v_add_f32 v153, 1.0, v153
    v_add_f32 v154, 1.0, v154
    v_add_f32 v155, 1.0, v155
    v_add_f32 v156, 1.0, v156
    v_add_f32 v157, 1.0, v157
    v_add_f32 v158, 1.0, v158
    v_add_f32 v159, 1.0, v159
    v_rcp_f32 v152, v152
    v_rcp_f32 v153, v153
    v_rcp_f32 v154, v154
    v_rcp_f32 v155, v155
    v_rcp_f32 v156, v156
    v_rcp_f32 v157, v157
    v_rcp_f32 v158, v158
    v_rcp_f32 v159, v159
    s_waitcnt vmcnt(0)
    v_lshlrev_b32 v160, 16, v136
    v_and_b32 v161, 0xffff0000, v136
    v_lshlrev_b32 v162, 16, v137
    v_and_b32 v163, 0xffff0000, v137
    v_lshlrev_b32 v164, 16, v138
    v_and_b32 v165, 0xffff0000, v138
    v_lshlrev_b32 v166, 16, v139
    v_and_b32 v167, 0xffff0000, v139
    v_mul_f32 v144, v144, v152
    v_mul_f32 v145, v145, v153
    v_mul_f32 v146, v146, v154
    v_mul_f32 v147, v147, v155
    v_mul_f32 v148, v148, v156
    v_mul_f32 v149, v149, v157
    v_mul_f32 v150, v150, v158
    v_mul_f32 v151, v151, v159
    s_waitcnt lgkmcnt(0)
    v_add_f32 v176, v176, v184
    v_add_f32 v192, v192, v200
    v_add_f32 v177, v177, v185
    v_add_f32 v193, v193, v201
    v_add_f32 v178, v178, v186
    v_add_f32 v194, v194, v202
    v_add_f32 v179, v179, v187
    v_add_f32 v195, v195, v203
    v_add_f32 v180, v180, v188
    v_add_f32 v196, v196, v204
    v_add_f32 v181, v181, v189
    v_add_f32 v197, v197, v205
    v_add_f32 v182, v182, v190
    v_add_f32 v198, v198, v206
    v_add_f32 v183, v183, v191
    v_add_f32 v199, v199, v207
    v_add_f32 v176, v176, v192
    v_add_f32 v177, v177, v193
    v_add_f32 v178, v178, v194
    v_add_f32 v179, v179, v195
    v_add_f32 v180, v180, v196
    v_add_f32 v181, v181, v197
    v_add_f32 v182, v182, v198
    v_add_f32 v183, v183, v199
    v_mul_f32 v184, 0xbfb8aa3b, v176
    v_mul_f32 v185, 0xbfb8aa3b, v177
    v_mul_f32 v186, 0xbfb8aa3b, v178
    v_mul_f32 v187, 0xbfb8aa3b, v179
    v_mul_f32 v188, 0xbfb8aa3b, v180
    v_mul_f32 v189, 0xbfb8aa3b, v181
    v_mul_f32 v190, 0xbfb8aa3b, v182
    v_mul_f32 v191, 0xbfb8aa3b, v183
    v_exp_f32 v184, v184
    v_exp_f32 v185, v185
    v_exp_f32 v186, v186
    v_exp_f32 v187, v187
    v_exp_f32 v188, v188
    v_exp_f32 v189, v189
    v_exp_f32 v190, v190
    v_exp_f32 v191, v191
    v_add_f32 v184, 1.0, v184
    v_add_f32 v185, 1.0, v185
    v_add_f32 v186, 1.0, v186
    v_add_f32 v187, 1.0, v187
    v_add_f32 v188, 1.0, v188
    v_add_f32 v189, 1.0, v189
    v_add_f32 v190, 1.0, v190
    v_add_f32 v191, 1.0, v191
    v_rcp_f32 v184, v184
    v_rcp_f32 v185, v185
    v_rcp_f32 v186, v186
    v_rcp_f32 v187, v187
    v_rcp_f32 v188, v188
    v_rcp_f32 v189, v189
    v_rcp_f32 v190, v190
    v_rcp_f32 v191, v191
    s_waitcnt vmcnt(0)
    v_lshlrev_b32 v192, 16, v140
    v_and_b32 v193, 0xffff0000, v140
    v_lshlrev_b32 v194, 16, v141
    v_and_b32 v195, 0xffff0000, v141
    v_lshlrev_b32 v196, 16, v142
    v_and_b32 v197, 0xffff0000, v142
    v_lshlrev_b32 v198, 16, v143
    v_and_b32 v199, 0xffff0000, v143
    v_mul_f32 v176, v176, v184
    v_mul_f32 v177, v177, v185
    v_mul_f32 v178, v178, v186
    v_mul_f32 v179, v179, v187
    v_mul_f32 v180, v180, v188
    v_mul_f32 v181, v181, v189
    v_mul_f32 v182, v182, v190
    v_mul_f32 v183, v183, v191
    s_barrier
    ds_read_b128 v[8:11], v254 offset:0
    ds_read_b128 v[12:15], v254 offset:512
    ds_read_b128 v[16:19], v254 offset:2112
    ds_read_b128 v[20:23], v254 offset:2624
    ds_read_b128 v[24:27], v254 offset:4224
    ds_read_b128 v[28:31], v254 offset:4736
    ds_read_b128 v[32:35], v254 offset:6336
    ds_read_b128 v[36:39], v254 offset:6848
    ds_read_b128 v[40:43], v254 offset:128
    ds_read_b128 v[44:47], v254 offset:640
    ds_read_b128 v[48:51], v254 offset:2240
    ds_read_b128 v[52:55], v254 offset:2752
    ds_read_b128 v[56:59], v254 offset:4352
    ds_read_b128 v[60:63], v254 offset:4864
    ds_read_b128 v[64:67], v254 offset:6464
    ds_read_b128 v[68:71], v254 offset:6976
    s_waitcnt lgkmcnt(8)
    v_pk_add_f32 v[8:9], v[8:9], v[16:17]
    v_pk_add_f32 v[24:25], v[24:25], v[32:33]
    v_pk_add_f32 v[10:11], v[10:11], v[18:19]
    v_pk_add_f32 v[26:27], v[26:27], v[34:35]
    v_pk_add_f32 v[12:13], v[12:13], v[20:21]
    v_pk_add_f32 v[28:29], v[28:29], v[36:37]
    v_pk_add_f32 v[14:15], v[14:15], v[22:23]
    v_pk_add_f32 v[30:31], v[30:31], v[38:39]
    v_pk_add_f32 v[8:9], v[8:9], v[24:25]
    v_pk_add_f32 v[10:11], v[10:11], v[26:27]
    v_pk_add_f32 v[12:13], v[12:13], v[28:29]
    v_pk_add_f32 v[14:15], v[14:15], v[30:31]
    v_pk_fma_f32 v[8:9], v[8:9], v[144:145], v[160:161]
    v_pk_fma_f32 v[10:11], v[10:11], v[146:147], v[162:163]
    v_pk_fma_f32 v[12:13], v[12:13], v[148:149], v[164:165]
    v_pk_fma_f32 v[14:15], v[14:15], v[150:151], v[166:167]
    v_cvt_pk_bf16_f32 v8, v8, v9
    v_cvt_pk_bf16_f32 v9, v10, v11
    v_cvt_pk_bf16_f32 v10, v12, v13
    v_cvt_pk_bf16_f32 v11, v14, v15
    buffer_store_dwordx4 v[8:11], v245, s[32:35], s70 offen sc1
    s_waitcnt lgkmcnt(0)
    v_pk_add_f32 v[40:41], v[40:41], v[48:49]
    v_pk_add_f32 v[56:57], v[56:57], v[64:65]
    v_pk_add_f32 v[42:43], v[42:43], v[50:51]
    v_pk_add_f32 v[58:59], v[58:59], v[66:67]
    v_pk_add_f32 v[44:45], v[44:45], v[52:53]
    v_pk_add_f32 v[60:61], v[60:61], v[68:69]
    v_pk_add_f32 v[46:47], v[46:47], v[54:55]
    v_pk_add_f32 v[62:63], v[62:63], v[70:71]
    v_pk_add_f32 v[40:41], v[40:41], v[56:57]
    v_pk_add_f32 v[42:43], v[42:43], v[58:59]
    v_pk_add_f32 v[44:45], v[44:45], v[60:61]
    v_pk_add_f32 v[46:47], v[46:47], v[62:63]
    v_pk_fma_f32 v[40:41], v[40:41], v[176:177], v[192:193]
    v_pk_fma_f32 v[42:43], v[42:43], v[178:179], v[194:195]
    v_pk_fma_f32 v[44:45], v[44:45], v[180:181], v[196:197]
    v_pk_fma_f32 v[46:47], v[46:47], v[182:183], v[198:199]
    v_cvt_pk_bf16_f32 v40, v40, v41
    v_cvt_pk_bf16_f32 v41, v42, v43
    v_cvt_pk_bf16_f32 v42, v44, v45
    v_cvt_pk_bf16_f32 v43, v46, v47
    buffer_store_dwordx4 v[40:43], v245, s[32:35], s64 offen sc1
Lend:
    s_endpgm
LFkv:
    s_setprio 0
    s_lshl_b32 s58, s47, 12
    s_add_u32 s57, s58, 36864
    s_mov_b32 m0, s57
    s_nop 0
    buffer_load_dwordx4 v244, s[40:43], s57 offen offset:0 sc1 lds
    buffer_load_dwordx4 v244, s[40:43], s57 offen offset:1024 sc1 lds
    buffer_load_dwordx4 v244, s[40:43], s57 offen offset:2048 sc1 lds
    buffer_load_dwordx4 v244, s[40:43], s57 offen offset:3072 sc1 lds
    s_add_u32 s57, s58, 53248
    s_mov_b32 m0, s57
    s_nop 0
    buffer_load_dwordx4 v244, s[40:43], s57 offen offset:0 sc1 lds
    buffer_load_dwordx4 v244, s[40:43], s57 offen offset:1024 sc1 lds
    buffer_load_dwordx4 v244, s[40:43], s57 offen offset:2048 sc1 lds
    buffer_load_dwordx4 v244, s[40:43], s57 offen offset:3072 sc1 lds
    s_add_u32 s57, s58, 69632
    s_mov_b32 m0, s57
    s_nop 0
    buffer_load_dwordx4 v244, s[40:43], s57 offen offset:0 sc1 lds
    buffer_load_dwordx4 v244, s[40:43], s57 offen offset:1024 sc1 lds
    buffer_load_dwordx4 v244, s[40:43], s57 offen offset:2048 sc1 lds
    buffer_load_dwordx4 v244, s[40:43], s57 offen offset:3072 sc1 lds
    s_add_u32 s57, s58, 86016
    s_mov_b32 m0, s57
    s_nop 0
    buffer_load_dwordx4 v244, s[40:43], s57 offen offset:0 sc1 lds
    buffer_load_dwordx4 v244, s[40:43], s57 offen offset:1024 sc1 lds
    buffer_load_dwordx4 v244, s[40:43], s57 offen offset:2048 sc1 lds
    buffer_load_dwordx4 v244, s[40:43], s57 offen offset:3072 sc1 lds
    s_add_u32 s57, s58, 102400
    s_mov_b32 m0, s57
    s_nop 0
    buffer_load_dwordx4 v244, s[40:43], s57 offen offset:0 sc1 lds
    buffer_load_dwordx4 v244, s[40:43], s57 offen offset:1024 sc1 lds
    buffer_load_dwordx4 v244, s[40:43], s57 offen offset:2048 sc1 lds
    buffer_load_dwordx4 v244, s[40:43], s57 offen offset:3072 sc1 lds
    s_add_u32 s57, s58, 118784
    s_mov_b32 m0, s57
    s_nop 0
    buffer_load_dwordx4 v244, s[40:43], s57 offen offset:0 sc1 lds
    buffer_load_dwordx4 v244, s[40:43], s57 offen offset:1024 sc1 lds
    buffer_load_dwordx4 v244, s[40:43], s57 offen offset:2048 sc1 lds
    buffer_load_dwordx4 v244, s[40:43], s57 offen offset:3072 sc1 lds
    buffer_load_dwordx2 v[246:247], off, s[36:39], 0 sc1
    s_setprio 2
LF:
    s_lshl_b32 s57, s44, 2
    s_add_u32 s57, s57, s47
    s_lshl_b32 s57, s57, 5
    s_lshr_b32 s58, s45, 1
    s_add_u32 s57, s57, s58
    s_and_b32 s58, s45, 1
    s_lshl_b32 s58, s58, 4
    s_add_u32 s57, s57, s58
    s_lshl_b32 s57, s57, 10
    s_add_u32 s98, s57, 5902336
    s_add_u32 s99, s98, 8192
    v_mov_b64 v[232:233], -1
    v_mov_b64 v[234:235], -1
    buffer_store_dwordx4 v[232:235], v244, s[40:43], s98 offen sc1
    buffer_store_dwordx4 v[232:235], v244, s[40:43], s99 offen sc1
    s_mov_b32 s57, 0
    s_waitcnt vmcnt(0)
Ltag_f:
    v_readfirstlane_b32 s86, v246
    v_readfirstlane_b32 s87, v247
    s_add_u32 s57, s57, 1
    s_cmp_lg_u32 s86, 0
    s_cbranch_scc1 Ltagd_f
    s_cmp_ge_u32 s57, 100000
    s_cbranch_scc1 Ltagd_f
Ltagr_f:
    s_sleep 1
    buffer_load_dwordx2 v[246:247], off, s[36:39], 0 sc1
    s_waitcnt vmcnt(0)
    s_branch Ltag_f
Ltagd_f:
    s_setprio 0
    s_barrier
    s_cmp_lg_u32 s46, 4
    s_cbranch_scc1 Lsig_h
    v_mov_b32 v246, s86
    v_mov_b32 v247, s87
    s_mov_b64 exec, 1
    buffer_store_dwordx2 v[246:247], off, s[40:43], s73 sc1
    s_mov_b64 exec, -1
Lsig_h:
    s_add_u32 m0, s68, 135168
    s_add_u32 s57, s67, 0
    buffer_load_dwordx4 v243, s[20:23], s57 offen lds
    buffer_load_dwordx4 v255, s[20:23], s57 offen offset:1024 lds
    s_add_u32 m0, s68, 143360
    s_add_u32 s57, s67, 65536
    buffer_load_dwordx4 v243, s[20:23], s57 offen lds
    buffer_load_dwordx4 v255, s[20:23], s57 offen offset:1024 lds
    s_add_u32 m0, s68, 151552
    s_add_u32 s57, s67, 131072
    buffer_load_dwordx4 v243, s[20:23], s57 offen lds
    buffer_load_dwordx4 v255, s[20:23], s57 offen offset:1024 lds
    s_add_u32 m0, s68, 0
    s_add_u32 s57, s67, 196608
    buffer_load_dwordx4 v243, s[20:23], s57 offen lds
    buffer_load_dwordx4 v255, s[20:23], s57 offen offset:1024 lds
    s_add_u32 m0, s68, 8320
    s_add_u32 s57, s67, 262144
    buffer_load_dwordx4 v243, s[20:23], s57 offen lds
    buffer_load_dwordx4 v255, s[20:23], s57 offen offset:1024 lds
    s_add_u32 m0, s68, 16640
    s_add_u32 s57, s67, 327680
    buffer_load_dwordx4 v243, s[20:23], s57 offen lds
    buffer_load_dwordx4 v255, s[20:23], s57 offen offset:1024 lds
    s_add_u32 m0, s68, 24960
    s_add_u32 s57, s67, 393216
    buffer_load_dwordx4 v243, s[20:23], s57 offen lds
    buffer_load_dwordx4 v255, s[20:23], s57 offen offset:1024 lds
    s_waitcnt vmcnt(12)
    ds_read_b64_tr_b16 v[72:73], v250 offset:0
    ds_read_b64_tr_b16 v[74:75], v250 offset:1024
    ds_read_b64_tr_b16 v[76:77], v251 offset:0
    ds_read_b64_tr_b16 v[78:79], v251 offset:1024
    s_waitcnt lgkmcnt(0)
    s_add_u32 m0, s68, 135168
    s_add_u32 s57, s67, 458752
    buffer_load_dwordx4 v243, s[20:23], s57 offen lds
    buffer_load_dwordx4 v255, s[20:23], s57 offen offset:1024 lds
    s_waitcnt vmcnt(12)
    ds_read_b64_tr_b16 v[80:81], v250 offset:8192
    ds_read_b64_tr_b16 v[82:83], v250 offset:9216
    ds_read_b64_tr_b16 v[84:85], v251 offset:8192
    ds_read_b64_tr_b16 v[86:87], v251 offset:9216
    s_waitcnt lgkmcnt(0)
    s_add_u32 m0, s68, 143360
    s_add_u32 s57, s67, 0
    buffer_load_dwordx4 v243, s[28:31], s57 offen lds
    buffer_load_dwordx4 v255, s[28:31], s57 offen offset:1024 lds
    s_waitcnt vmcnt(12)
    ds_read_b64_tr_b16 v[88:89], v250 offset:16384
    ds_read_b64_tr_b16 v[90:91], v250 offset:17408
    ds_read_b64_tr_b16 v[92:93], v251 offset:16384
    ds_read_b64_tr_b16 v[94:95], v251 offset:17408
    s_waitcnt lgkmcnt(0)
    s_add_u32 m0, s68, 151552
    s_add_u32 s57, s67, 65536
    buffer_load_dwordx4 v243, s[28:31], s57 offen lds
    buffer_load_dwordx4 v255, s[28:31], s57 offen offset:1024 lds
    s_waitcnt vmcnt(12)
    ds_read_b64_tr_b16 v[96:97], v248 offset:0
    ds_read_b64_tr_b16 v[98:99], v248 offset:1024
    ds_read_b64_tr_b16 v[100:101], v249 offset:0
    ds_read_b64_tr_b16 v[102:103], v249 offset:1024
    s_waitcnt lgkmcnt(0)
    s_add_u32 m0, s68, 0
    s_add_u32 s57, s67, 131072
    buffer_load_dwordx4 v243, s[28:31], s57 offen lds
    buffer_load_dwordx4 v255, s[28:31], s57 offen offset:1024 lds
    s_waitcnt vmcnt(12)
    ds_read_b64_tr_b16 v[104:105], v248 offset:8320
    ds_read_b64_tr_b16 v[106:107], v248 offset:9344
    ds_read_b64_tr_b16 v[108:109], v249 offset:8320
    ds_read_b64_tr_b16 v[110:111], v249 offset:9344
    s_waitcnt lgkmcnt(0)
    s_add_u32 m0, s68, 8320
    s_add_u32 s57, s67, 196608
    buffer_load_dwordx4 v243, s[28:31], s57 offen lds
    buffer_load_dwordx4 v255, s[28:31], s57 offen offset:1024 lds
    s_waitcnt vmcnt(12)
    ds_read_b64_tr_b16 v[112:113], v248 offset:16640
    ds_read_b64_tr_b16 v[114:115], v248 offset:17664
    ds_read_b64_tr_b16 v[116:117], v249 offset:16640
    ds_read_b64_tr_b16 v[118:119], v249 offset:17664
    s_waitcnt lgkmcnt(0)
    s_add_u32 m0, s68, 16640
    s_add_u32 s57, s67, 262144
    buffer_load_dwordx4 v243, s[28:31], s57 offen lds
    buffer_load_dwordx4 v255, s[28:31], s57 offen offset:1024 lds
    s_waitcnt vmcnt(12)
    ds_read_b64_tr_b16 v[120:121], v248 offset:24960
    ds_read_b64_tr_b16 v[122:123], v248 offset:25984
    ds_read_b64_tr_b16 v[124:125], v249 offset:24960
    ds_read_b64_tr_b16 v[126:127], v249 offset:25984
    s_waitcnt lgkmcnt(0)
    s_add_u32 m0, s68, 24960
    s_add_u32 s57, s67, 327680
    buffer_load_dwordx4 v243, s[28:31], s57 offen lds
    buffer_load_dwordx4 v255, s[28:31], s57 offen offset:1024 lds
    s_waitcnt vmcnt(12)
    ds_read_b64_tr_b16 v[128:129], v250 offset:0
    ds_read_b64_tr_b16 v[130:131], v250 offset:1024
    ds_read_b64_tr_b16 v[132:133], v251 offset:0
    ds_read_b64_tr_b16 v[134:135], v251 offset:1024
    s_waitcnt lgkmcnt(0)
    s_add_u32 m0, s68, 135168
    s_add_u32 s57, s67, 393216
    buffer_load_dwordx4 v243, s[28:31], s57 offen lds
    buffer_load_dwordx4 v255, s[28:31], s57 offen offset:1024 lds
    v_and_b32 v246, 15, v1
    v_lshlrev_b32 v246, 7, v246
    buffer_load_dwordx2 v[246:247], v246, s[40:43], s69 offen sc1
    s_mov_b32 s57, 0
    s_waitcnt vmcnt(0)
Lfw_h:
    v_cmp_ne_u64 vcc, s[86:87], v[246:247]
    s_add_u32 s57, s57, 1
    s_cmp_ge_u32 s57, 100000
    s_cbranch_vccz Lfwd_h
    s_cbranch_scc1 Lfwd_h
    s_sleep 3
    v_and_b32 v246, 15, v1
    v_lshlrev_b32 v246, 7, v246
    buffer_load_dwordx2 v[246:247], v246, s[40:43], s69 offen sc1
    s_waitcnt vmcnt(0)
    s_branch Lfw_h
Lfwd_h:
    s_add_u32 s94, s66, 0
    s_add_u32 s95, s94, 90112
    buffer_load_dwordx4 v[152:155], v244, s[40:43], s94 offen offset:0 sc1
    buffer_load_dwordx4 v[156:159], v244, s[40:43], s95 offen offset:0 sc1
    buffer_load_dwordx4 v[160:163], v244, s[40:43], s94 offen offset:1024 sc1
    buffer_load_dwordx4 v[164:167], v244, s[40:43], s95 offen offset:1024 sc1
    buffer_load_dwordx4 v[168:171], v244, s[40:43], s94 offen offset:2048 sc1
    buffer_load_dwordx4 v[172:175], v244, s[40:43], s95 offen offset:2048 sc1
    buffer_load_dwordx4 v[176:179], v244, s[40:43], s94 offen offset:3072 sc1
    buffer_load_dwordx4 v[180:183], v244, s[40:43], s95 offen offset:3072 sc1
    s_add_u32 s94, s66, 4096
    s_add_u32 s95, s94, 90112
    buffer_load_dwordx4 v[184:187], v244, s[40:43], s94 offen offset:0 sc1
    buffer_load_dwordx4 v[188:191], v244, s[40:43], s95 offen offset:0 sc1
    buffer_load_dwordx4 v[192:195], v244, s[40:43], s94 offen offset:1024 sc1
    buffer_load_dwordx4 v[196:199], v244, s[40:43], s95 offen offset:1024 sc1
    buffer_load_dwordx4 v[200:203], v244, s[40:43], s94 offen offset:2048 sc1
    buffer_load_dwordx4 v[204:207], v244, s[40:43], s95 offen offset:2048 sc1
    buffer_load_dwordx4 v[208:211], v244, s[40:43], s94 offen offset:3072 sc1
    buffer_load_dwordx4 v[212:215], v244, s[40:43], s95 offen offset:3072 sc1
    ds_read_b64_tr_b16 v[136:137], v250 offset:8192
    ds_read_b64_tr_b16 v[138:139], v250 offset:9216
    ds_read_b64_tr_b16 v[140:141], v251 offset:8192
    ds_read_b64_tr_b16 v[142:143], v251 offset:9216
    s_waitcnt vmcnt(10)
    ds_read_b64_tr_b16 v[144:145], v250 offset:16384
    ds_read_b64_tr_b16 v[146:147], v250 offset:17408
    ds_read_b64_tr_b16 v[148:149], v251 offset:16384
    ds_read_b64_tr_b16 v[150:151], v251 offset:17408
    s_waitcnt lgkmcnt(4)
    s_add_u32 m0, s68, 143360
    s_add_u32 s57, s67, 458752
    buffer_load_dwordx4 v243, s[28:31], s57 offen lds
    buffer_load_dwordx4 v255, s[28:31], s57 offen offset:1024 lds
    s_waitcnt vmcnt(14)
    v_mfma_f32_32x32x16_bf16 v[8:23], v[136:139], v[152:155], 0
    v_mfma_f32_32x32x16_bf16 v[24:39], v[140:143], v[152:155], 0
    v_mfma_f32_32x32x16_bf16 v[40:55], v[136:139], v[156:159], 0
    v_mfma_f32_32x32x16_bf16 v[56:71], v[140:143], v[156:159], 0
    s_add_u32 s94, s66, 8192
    s_add_u32 s95, s94, 90112
    buffer_load_dwordx4 v[152:155], v244, s[40:43], s94 offen offset:0 sc1
    buffer_load_dwordx4 v[156:159], v244, s[40:43], s95 offen offset:0 sc1
    s_waitcnt vmcnt(10)
    ds_read_b64_tr_b16 v[136:137], v248 offset:0
    ds_read_b64_tr_b16 v[138:139], v248 offset:1024
    ds_read_b64_tr_b16 v[140:141], v249 offset:0
    ds_read_b64_tr_b16 v[142:143], v249 offset:1024
    s_waitcnt lgkmcnt(4)
    s_add_u32 m0, s68, 151552
    s_add_u32 s57, s67, 524288
    buffer_load_dwordx4 v243, s[28:31], s57 offen lds
    buffer_load_dwordx4 v255, s[28:31], s57 offen offset:1024 lds
    s_waitcnt vmcnt(14)
    v_mfma_f32_32x32x16_bf16 v[8:23], v[144:147], v[160:163], v[8:23]
    v_mfma_f32_32x32x16_bf16 v[24:39], v[148:151], v[160:163], v[24:39]
    v_mfma_f32_32x32x16_bf16 v[40:55], v[144:147], v[164:167], v[40:55]
    v_mfma_f32_32x32x16_bf16 v[56:71], v[148:151], v[164:167], v[56:71]
    buffer_load_dwordx4 v[160:163], v244, s[40:43], s94 offen offset:1024 sc1
    buffer_load_dwordx4 v[164:167], v244, s[40:43], s95 offen offset:1024 sc1
    s_waitcnt vmcnt(10)
    ds_read_b64_tr_b16 v[144:145], v248 offset:8320
    ds_read_b64_tr_b16 v[146:147], v248 offset:9344
    ds_read_b64_tr_b16 v[148:149], v249 offset:8320
    ds_read_b64_tr_b16 v[150:151], v249 offset:9344
    s_waitcnt lgkmcnt(4)
    s_add_u32 m0, s68, 0
    s_add_u32 s57, s67, 589824
    buffer_load_dwordx4 v243, s[28:31], s57 offen lds
    buffer_load_dwordx4 v255, s[28:31], s57 offen offset:1024 lds
    s_waitcnt vmcnt(14)
    v_mfma_f32_32x32x16_bf16 v[8:23], v[136:139], v[168:171], v[8:23]
    v_mfma_f32_32x32x16_bf16 v[24:39], v[140:143], v[168:171], v[24:39]
    v_mfma_f32_32x32x16_bf16 v[40:55], v[136:139], v[172:175], v[40:55]
    v_mfma_f32_32x32x16_bf16 v[56:71], v[140:143], v[172:175], v[56:71]
    buffer_load_dwordx4 v[168:171], v244, s[40:43], s94 offen offset:2048 sc1
    buffer_load_dwordx4 v[172:175], v244, s[40:43], s95 offen offset:2048 sc1
    s_waitcnt vmcnt(10)
    ds_read_b64_tr_b16 v[136:137], v248 offset:16640
    ds_read_b64_tr_b16 v[138:139], v248 offset:17664
    ds_read_b64_tr_b16 v[140:141], v249 offset:16640
    ds_read_b64_tr_b16 v[142:143], v249 offset:17664
    s_waitcnt lgkmcnt(4)
    s_add_u32 m0, s68, 8320
    s_add_u32 s57, s67, 655360
    buffer_load_dwordx4 v243, s[28:31], s57 offen lds
    buffer_load_dwordx4 v255, s[28:31], s57 offen offset:1024 lds
    s_waitcnt vmcnt(14)
    v_mfma_f32_32x32x16_bf16 v[8:23], v[144:147], v[176:179], v[8:23]
    v_mfma_f32_32x32x16_bf16 v[24:39], v[148:151], v[176:179], v[24:39]
    v_mfma_f32_32x32x16_bf16 v[40:55], v[144:147], v[180:183], v[40:55]
    v_mfma_f32_32x32x16_bf16 v[56:71], v[148:151], v[180:183], v[56:71]
    buffer_load_dwordx4 v[176:179], v244, s[40:43], s94 offen offset:3072 sc1
    buffer_load_dwordx4 v[180:183], v244, s[40:43], s95 offen offset:3072 sc1
    s_waitcnt vmcnt(10)
    ds_read_b64_tr_b16 v[144:145], v248 offset:24960
    ds_read_b64_tr_b16 v[146:147], v248 offset:25984
    ds_read_b64_tr_b16 v[148:149], v249 offset:24960
    ds_read_b64_tr_b16 v[150:151], v249 offset:25984
    s_waitcnt lgkmcnt(4)
    s_add_u32 m0, s68, 16640
    s_add_u32 s57, s67, 720896
    buffer_load_dwordx4 v243, s[28:31], s57 offen lds
    buffer_load_dwordx4 v255, s[28:31], s57 offen offset:1024 lds
    s_waitcnt vmcnt(14)
    v_mfma_f32_32x32x16_bf16 v[8:23], v[136:139], v[184:187], v[8:23]
    v_mfma_f32_32x32x16_bf16 v[24:39], v[140:143], v[184:187], v[24:39]
    v_mfma_f32_32x32x16_bf16 v[40:55], v[136:139], v[188:191], v[40:55]
    v_mfma_f32_32x32x16_bf16 v[56:71], v[140:143], v[188:191], v[56:71]
    s_add_u32 s94, s66, 12288
    s_add_u32 s95, s94, 90112
    buffer_load_dwordx4 v[184:187], v244, s[40:43], s94 offen offset:0 sc1
    buffer_load_dwordx4 v[188:191], v244, s[40:43], s95 offen offset:0 sc1
    s_waitcnt vmcnt(10)
    ds_read_b64_tr_b16 v[136:137], v250 offset:0
    ds_read_b64_tr_b16 v[138:139], v250 offset:1024
    ds_read_b64_tr_b16 v[140:141], v251 offset:0
    ds_read_b64_tr_b16 v[142:143], v251 offset:1024
    s_waitcnt lgkmcnt(4)
    s_add_u32 m0, s68, 24960
    s_add_u32 s57, s67, 786432
    buffer_load_dwordx4 v243, s[28:31], s57 offen lds
    buffer_load_dwordx4 v255, s[28:31], s57 offen offset:1024 lds
    s_waitcnt vmcnt(14)
    v_mfma_f32_32x32x16_bf16 v[8:23], v[144:147], v[192:195], v[8:23]
    v_mfma_f32_32x32x16_bf16 v[24:39], v[148:151], v[192:195], v[24:39]
    v_mfma_f32_32x32x16_bf16 v[40:55], v[144:147], v[196:199], v[40:55]
    v_mfma_f32_32x32x16_bf16 v[56:71], v[148:151], v[196:199], v[56:71]
    buffer_load_dwordx4 v[192:195], v244, s[40:43], s94 offen offset:1024 sc1
    buffer_load_dwordx4 v[196:199], v244, s[40:43], s95 offen offset:1024 sc1
    s_waitcnt vmcnt(10)
    ds_read_b64_tr_b16 v[144:145], v250 offset:8192
    ds_read_b64_tr_b16 v[146:147], v250 offset:9216
    ds_read_b64_tr_b16 v[148:149], v251 offset:8192
    ds_read_b64_tr_b16 v[150:151], v251 offset:9216
    s_waitcnt lgkmcnt(4)
    s_add_u32 m0, s68, 135168
    s_add_u32 s57, s67, 851968
    buffer_load_dwordx4 v243, s[28:31], s57 offen lds
    buffer_load_dwordx4 v255, s[28:31], s57 offen offset:1024 lds
    s_waitcnt vmcnt(14)
    v_mfma_f32_32x32x16_bf16 v[8:23], v[136:139], v[200:203], v[8:23]
    v_mfma_f32_32x32x16_bf16 v[24:39], v[140:143], v[200:203], v[24:39]
    v_mfma_f32_32x32x16_bf16 v[40:55], v[136:139], v[204:207], v[40:55]
    v_mfma_f32_32x32x16_bf16 v[56:71], v[140:143], v[204:207], v[56:71]
    buffer_load_dwordx4 v[200:203], v244, s[40:43], s94 offen offset:2048 sc1
    buffer_load_dwordx4 v[204:207], v244, s[40:43], s95 offen offset:2048 sc1
    s_waitcnt vmcnt(10)
    ds_read_b64_tr_b16 v[136:137], v250 offset:16384
    ds_read_b64_tr_b16 v[138:139], v250 offset:17408
    ds_read_b64_tr_b16 v[140:141], v251 offset:16384
    ds_read_b64_tr_b16 v[142:143], v251 offset:17408
    s_waitcnt lgkmcnt(4)
    s_add_u32 m0, s68, 143360
    s_add_u32 s57, s67, 917504
    buffer_load_dwordx4 v243, s[28:31], s57 offen lds
    buffer_load_dwordx4 v255, s[28:31], s57 offen offset:1024 lds
    s_waitcnt vmcnt(14)
    v_mfma_f32_32x32x16_bf16 v[8:23], v[144:147], v[208:211], v[8:23]
    v_mfma_f32_32x32x16_bf16 v[24:39], v[148:151], v[208:211], v[24:39]
    v_mfma_f32_32x32x16_bf16 v[40:55], v[144:147], v[212:215], v[40:55]
    v_mfma_f32_32x32x16_bf16 v[56:71], v[148:151], v[212:215], v[56:71]
    buffer_load_dwordx4 v[208:211], v244, s[40:43], s94 offen offset:3072 sc1
    buffer_load_dwordx4 v[212:215], v244, s[40:43], s95 offen offset:3072 sc1
    s_waitcnt vmcnt(10)
    ds_read_b64_tr_b16 v[144:145], v248 offset:0
    ds_read_b64_tr_b16 v[146:147], v248 offset:1024
    ds_read_b64_tr_b16 v[148:149], v249 offset:0
    ds_read_b64_tr_b16 v[150:151], v249 offset:1024
    s_waitcnt lgkmcnt(4)
    s_add_u32 m0, s68, 151552
    s_add_u32 s57, s67, 983040
    buffer_load_dwordx4 v243, s[28:31], s57 offen lds
    buffer_load_dwordx4 v255, s[28:31], s57 offen offset:1024 lds
    s_waitcnt vmcnt(14)
    v_mfma_f32_32x32x16_bf16 v[8:23], v[136:139], v[152:155], v[8:23]
    v_mfma_f32_32x32x16_bf16 v[24:39], v[140:143], v[152:155], v[24:39]
    v_mfma_f32_32x32x16_bf16 v[40:55], v[136:139], v[156:159], v[40:55]
    v_mfma_f32_32x32x16_bf16 v[56:71], v[140:143], v[156:159], v[56:71]
    s_add_u32 s94, s66, 16384
    s_add_u32 s95, s94, 90112
    buffer_load_dwordx4 v[152:155], v244, s[40:43], s94 offen offset:0 sc1
    buffer_load_dwordx4 v[156:159], v244, s[40:43], s95 offen offset:0 sc1
    s_waitcnt vmcnt(10)
    ds_read_b64_tr_b16 v[136:137], v248 offset:8320
    ds_read_b64_tr_b16 v[138:139], v248 offset:9344
    ds_read_b64_tr_b16 v[140:141], v249 offset:8320
    ds_read_b64_tr_b16 v[142:143], v249 offset:9344
    s_waitcnt lgkmcnt(4)
    s_add_u32 m0, s68, 0
    s_add_u32 s57, s67, 1048576
    buffer_load_dwordx4 v243, s[28:31], s57 offen lds
    buffer_load_dwordx4 v255, s[28:31], s57 offen offset:1024 lds
    s_waitcnt vmcnt(14)
    v_mfma_f32_32x32x16_bf16 v[8:23], v[144:147], v[160:163], v[8:23]
    v_mfma_f32_32x32x16_bf16 v[24:39], v[148:151], v[160:163], v[24:39]
    v_mfma_f32_32x32x16_bf16 v[40:55], v[144:147], v[164:167], v[40:55]
    v_mfma_f32_32x32x16_bf16 v[56:71], v[148:151], v[164:167], v[56:71]
    buffer_load_dwordx4 v[160:163], v244, s[40:43], s94 offen offset:1024 sc1
    buffer_load_dwordx4 v[164:167], v244, s[40:43], s95 offen offset:1024 sc1
    s_waitcnt vmcnt(10)
    ds_read_b64_tr_b16 v[144:145], v248 offset:16640
    ds_read_b64_tr_b16 v[146:147], v248 offset:17664
    ds_read_b64_tr_b16 v[148:149], v249 offset:16640
    ds_read_b64_tr_b16 v[150:151], v249 offset:17664
    s_waitcnt lgkmcnt(4)
    s_add_u32 m0, s68, 8320
    s_add_u32 s57, s67, 1114112
    buffer_load_dwordx4 v243, s[28:31], s57 offen lds
    buffer_load_dwordx4 v255, s[28:31], s57 offen offset:1024 lds
    s_waitcnt vmcnt(14)
    v_mfma_f32_32x32x16_bf16 v[8:23], v[136:139], v[168:171], v[8:23]
    v_mfma_f32_32x32x16_bf16 v[24:39], v[140:143], v[168:171], v[24:39]
    v_mfma_f32_32x32x16_bf16 v[40:55], v[136:139], v[172:175], v[40:55]
    v_mfma_f32_32x32x16_bf16 v[56:71], v[140:143], v[172:175], v[56:71]
    buffer_load_dwordx4 v[168:171], v244, s[40:43], s94 offen offset:2048 sc1
    buffer_load_dwordx4 v[172:175], v244, s[40:43], s95 offen offset:2048 sc1
    s_waitcnt vmcnt(10)
    ds_read_b64_tr_b16 v[136:137], v248 offset:24960
    ds_read_b64_tr_b16 v[138:139], v248 offset:25984
    ds_read_b64_tr_b16 v[140:141], v249 offset:24960
    ds_read_b64_tr_b16 v[142:143], v249 offset:25984
    s_waitcnt lgkmcnt(4)
    s_add_u32 m0, s68, 16640
    s_add_u32 s57, s67, 1179648
    buffer_load_dwordx4 v243, s[28:31], s57 offen lds
    buffer_load_dwordx4 v255, s[28:31], s57 offen offset:1024 lds
    s_waitcnt vmcnt(14)
    v_mfma_f32_32x32x16_bf16 v[8:23], v[144:147], v[176:179], v[8:23]
    v_mfma_f32_32x32x16_bf16 v[24:39], v[148:151], v[176:179], v[24:39]
    v_mfma_f32_32x32x16_bf16 v[40:55], v[144:147], v[180:183], v[40:55]
    v_mfma_f32_32x32x16_bf16 v[56:71], v[148:151], v[180:183], v[56:71]
    buffer_load_dwordx4 v[176:179], v244, s[40:43], s94 offen offset:3072 sc1
    buffer_load_dwordx4 v[180:183], v244, s[40:43], s95 offen offset:3072 sc1
    s_waitcnt vmcnt(10)
    ds_read_b64_tr_b16 v[144:145], v250 offset:0
    ds_read_b64_tr_b16 v[146:147], v250 offset:1024
    ds_read_b64_tr_b16 v[148:149], v251 offset:0
    ds_read_b64_tr_b16 v[150:151], v251 offset:1024
    s_waitcnt lgkmcnt(4)
    s_add_u32 m0, s68, 24960
    s_add_u32 s57, s67, 1245184
    buffer_load_dwordx4 v243, s[28:31], s57 offen lds
    buffer_load_dwordx4 v255, s[28:31], s57 offen offset:1024 lds
    s_waitcnt vmcnt(14)
    v_mfma_f32_32x32x16_bf16 v[8:23], v[136:139], v[184:187], v[8:23]
    v_mfma_f32_32x32x16_bf16 v[24:39], v[140:143], v[184:187], v[24:39]
    v_mfma_f32_32x32x16_bf16 v[40:55], v[136:139], v[188:191], v[40:55]
    v_mfma_f32_32x32x16_bf16 v[56:71], v[140:143], v[188:191], v[56:71]
    s_add_u32 s94, s66, 20480
    s_add_u32 s95, s94, 90112
    buffer_load_dwordx4 v[184:187], v244, s[40:43], s94 offen offset:0 sc1
    buffer_load_dwordx4 v[188:191], v244, s[40:43], s95 offen offset:0 sc1
    s_waitcnt vmcnt(10)
    ds_read_b64_tr_b16 v[136:137], v250 offset:8192
    ds_read_b64_tr_b16 v[138:139], v250 offset:9216
    ds_read_b64_tr_b16 v[140:141], v251 offset:8192
    ds_read_b64_tr_b16 v[142:143], v251 offset:9216
    s_waitcnt lgkmcnt(4)
    s_add_u32 m0, s68, 135168
    s_add_u32 s57, s67, 1310720
    buffer_load_dwordx4 v243, s[28:31], s57 offen lds
    buffer_load_dwordx4 v255, s[28:31], s57 offen offset:1024 lds
    s_waitcnt vmcnt(14)
    v_mfma_f32_32x32x16_bf16 v[8:23], v[144:147], v[192:195], v[8:23]
    v_mfma_f32_32x32x16_bf16 v[24:39], v[148:151], v[192:195], v[24:39]
    v_mfma_f32_32x32x16_bf16 v[40:55], v[144:147], v[196:199], v[40:55]
    v_mfma_f32_32x32x16_bf16 v[56:71], v[148:151], v[196:199], v[56:71]
    buffer_load_dwordx4 v[192:195], v244, s[40:43], s94 offen offset:1024 sc1
    buffer_load_dwordx4 v[196:199], v244, s[40:43], s95 offen offset:1024 sc1
    s_waitcnt vmcnt(10)
    ds_read_b64_tr_b16 v[144:145], v250 offset:16384
    ds_read_b64_tr_b16 v[146:147], v250 offset:17408
    ds_read_b64_tr_b16 v[148:149], v251 offset:16384
    ds_read_b64_tr_b16 v[150:151], v251 offset:17408
    s_waitcnt lgkmcnt(4)
    s_add_u32 m0, s68, 143360
    s_add_u32 s57, s67, 1376256
    s_cmp_lt_u32 s47, 2
    s_cselect_b32 s57, s57, s67
    buffer_load_dwordx4 v243, s[28:31], s57 offen lds
    buffer_load_dwordx4 v255, s[28:31], s57 offen offset:1024 lds
    s_waitcnt vmcnt(14)
    v_mfma_f32_32x32x16_bf16 v[8:23], v[136:139], v[200:203], v[8:23]
    v_mfma_f32_32x32x16_bf16 v[24:39], v[140:143], v[200:203], v[24:39]
    v_mfma_f32_32x32x16_bf16 v[40:55], v[136:139], v[204:207], v[40:55]
    v_mfma_f32_32x32x16_bf16 v[56:71], v[140:143], v[204:207], v[56:71]
    s_barrier
    s_setprio 2
    s_waitcnt vmcnt(10)
    ds_read_b64_tr_b16 v[136:137], v248 offset:0
    ds_read_b64_tr_b16 v[138:139], v248 offset:1024
    ds_read_b64_tr_b16 v[140:141], v249 offset:0
    ds_read_b64_tr_b16 v[142:143], v249 offset:1024
    s_waitcnt lgkmcnt(4)
    s_waitcnt vmcnt(12)
    v_mfma_f32_32x32x16_bf16 v[8:23], v[144:147], v[208:211], v[8:23]
    v_mfma_f32_32x32x16_bf16 v[24:39], v[148:151], v[208:211], v[24:39]
    v_mfma_f32_32x32x16_bf16 v[40:55], v[144:147], v[212:215], v[40:55]
    v_mfma_f32_32x32x16_bf16 v[56:71], v[148:151], v[212:215], v[56:71]
    s_waitcnt vmcnt(8)
    ds_read_b64_tr_b16 v[144:145], v248 offset:8320
    ds_read_b64_tr_b16 v[146:147], v248 offset:9344
    ds_read_b64_tr_b16 v[148:149], v249 offset:8320
    ds_read_b64_tr_b16 v[150:151], v249 offset:9344
    s_waitcnt lgkmcnt(4)
    s_waitcnt vmcnt(10)
    v_mfma_f32_32x32x16_bf16 v[8:23], v[136:139], v[152:155], v[8:23]
    v_mfma_f32_32x32x16_bf16 v[24:39], v[140:143], v[152:155], v[24:39]
    v_mfma_f32_32x32x16_bf16 v[40:55], v[136:139], v[156:159], v[40:55]
    v_mfma_f32_32x32x16_bf16 v[56:71], v[140:143], v[156:159], v[56:71]
    s_waitcnt vmcnt(6)
    ds_read_b64_tr_b16 v[136:137], v248 offset:16640
    ds_read_b64_tr_b16 v[138:139], v248 offset:17664
    ds_read_b64_tr_b16 v[140:141], v249 offset:16640
    ds_read_b64_tr_b16 v[142:143], v249 offset:17664
    s_waitcnt lgkmcnt(4)
    s_waitcnt vmcnt(8)
    v_mfma_f32_32x32x16_bf16 v[8:23], v[144:147], v[160:163], v[8:23]
    v_mfma_f32_32x32x16_bf16 v[24:39], v[148:151], v[160:163], v[24:39]
    v_mfma_f32_32x32x16_bf16 v[40:55], v[144:147], v[164:167], v[40:55]
    v_mfma_f32_32x32x16_bf16 v[56:71], v[148:151], v[164:167], v[56:71]
    s_waitcnt vmcnt(4)
    ds_read_b64_tr_b16 v[144:145], v248 offset:24960
    ds_read_b64_tr_b16 v[146:147], v248 offset:25984
    ds_read_b64_tr_b16 v[148:149], v249 offset:24960
    ds_read_b64_tr_b16 v[150:151], v249 offset:25984
    s_waitcnt lgkmcnt(4)
    s_waitcnt vmcnt(6)
    v_mfma_f32_32x32x16_bf16 v[8:23], v[136:139], v[168:171], v[8:23]
    v_mfma_f32_32x32x16_bf16 v[24:39], v[140:143], v[168:171], v[24:39]
    v_mfma_f32_32x32x16_bf16 v[40:55], v[136:139], v[172:175], v[40:55]
    v_mfma_f32_32x32x16_bf16 v[56:71], v[140:143], v[172:175], v[56:71]
    s_waitcnt vmcnt(2)
    ds_read_b64_tr_b16 v[136:137], v250 offset:0
    ds_read_b64_tr_b16 v[138:139], v250 offset:1024
    ds_read_b64_tr_b16 v[140:141], v251 offset:0
    ds_read_b64_tr_b16 v[142:143], v251 offset:1024
    s_waitcnt lgkmcnt(4)
    s_waitcnt vmcnt(4)
    v_mfma_f32_32x32x16_bf16 v[8:23], v[144:147], v[176:179], v[8:23]
    v_mfma_f32_32x32x16_bf16 v[24:39], v[148:151], v[176:179], v[24:39]
    v_mfma_f32_32x32x16_bf16 v[40:55], v[144:147], v[180:183], v[40:55]
    v_mfma_f32_32x32x16_bf16 v[56:71], v[148:151], v[180:183], v[56:71]
    s_waitcnt vmcnt(0)
    ds_read_b64_tr_b16 v[144:145], v250 offset:8192
    ds_read_b64_tr_b16 v[146:147], v250 offset:9216
    ds_read_b64_tr_b16 v[148:149], v251 offset:8192
    ds_read_b64_tr_b16 v[150:151], v251 offset:9216
    s_waitcnt lgkmcnt(4)
    s_waitcnt vmcnt(2)
    v_mfma_f32_32x32x16_bf16 v[8:23], v[136:139], v[184:187], v[8:23]
    v_mfma_f32_32x32x16_bf16 v[24:39], v[140:143], v[184:187], v[24:39]
    v_mfma_f32_32x32x16_bf16 v[40:55], v[136:139], v[188:191], v[40:55]
    v_mfma_f32_32x32x16_bf16 v[56:71], v[140:143], v[188:191], v[56:71]
    s_waitcnt lgkmcnt(0)
    s_waitcnt vmcnt(0)
    s_cmp_ge_u32 s47, 2
    s_cbranch_scc1 Lskip21
    v_mfma_f32_32x32x16_bf16 v[8:23], v[144:147], v[192:195], v[8:23]
    v_mfma_f32_32x32x16_bf16 v[24:39], v[148:151], v[192:195], v[24:39]
    v_mfma_f32_32x32x16_bf16 v[40:55], v[144:147], v[196:199], v[40:55]
    v_mfma_f32_32x32x16_bf16 v[56:71], v[148:151], v[196:199], v[56:71]
Lskip21:
    s_nop 8
    ds_write_b128 v252, v[8:11] offset:0
    ds_write_b128 v252, v[12:15] offset:1056
    ds_write_b128 v252, v[16:19] offset:8512
    ds_write_b128 v252, v[20:23] offset:9568
    ds_write_b128 v252, v[24:27] offset:17024
    s_waitcnt lgkmcnt(4)
    buffer_load_dwordx4 v[8:11], v244, s[40:43], s72 offen offset:3072 sc1
    ds_write_b128 v252, v[28:31] offset:18080
    s_waitcnt lgkmcnt(4)
    buffer_load_dwordx4 v[12:15], v244, s[40:43], s81 offen offset:3072 sc1
    ds_write_b128 v252, v[32:35] offset:25536
    s_waitcnt lgkmcnt(4)
    buffer_load_dwordx4 v[16:19], v244, s[40:43], s72 offen offset:2048 sc1
    ds_write_b128 v252, v[36:39] offset:26592
    s_waitcnt lgkmcnt(4)
    buffer_load_dwordx4 v[20:23], v244, s[40:43], s81 offen offset:2048 sc1
    ds_write_b128 v252, v[40:43] offset:34048
    s_waitcnt lgkmcnt(4)
    buffer_load_dwordx4 v[24:27], v244, s[40:43], s72 offen offset:1024 sc1
    ds_write_b128 v252, v[44:47] offset:35104
    s_waitcnt lgkmcnt(4)
    buffer_load_dwordx4 v[28:31], v244, s[40:43], s81 offen offset:1024 sc1
    ds_write_b128 v252, v[48:51] offset:42560
    s_waitcnt lgkmcnt(4)
    buffer_load_dwordx4 v[32:35], v244, s[40:43], s72 offen offset:0 sc1
    ds_write_b128 v252, v[52:55] offset:43616
    s_waitcnt lgkmcnt(4)
    buffer_load_dwordx4 v[36:39], v244, s[40:43], s81 offen offset:0 sc1
    ds_write_b128 v252, v[56:59] offset:51072
    s_waitcnt lgkmcnt(4)
    buffer_load_dwordx4 v[40:43], v244, s[40:43], s71 offen offset:1024 sc1
    ds_write_b128 v252, v[60:63] offset:52128
    s_waitcnt lgkmcnt(4)
    buffer_load_dwordx4 v[44:47], v244, s[40:43], s80 offen offset:1024 sc1
    ds_write_b128 v252, v[64:67] offset:59584
    s_waitcnt lgkmcnt(4)
    buffer_load_dwordx4 v[48:51], v244, s[40:43], s71 offen offset:0 sc1
    ds_write_b128 v252, v[68:71] offset:60640
    s_waitcnt lgkmcnt(4)
    buffer_load_dwordx4 v[52:55], v244, s[40:43], s80 offen offset:0 sc1
    s_waitcnt lgkmcnt(0)
    s_barrier
    buffer_load_dwordx4 v[56:59], v244, s[40:43], s71 offen offset:3072 sc1
    buffer_load_dwordx4 v[60:63], v244, s[40:43], s80 offen offset:3072 sc1
    buffer_load_dwordx4 v[64:67], v244, s[40:43], s71 offen offset:2048 sc1
    buffer_load_dwordx4 v[68:71], v244, s[40:43], s80 offen offset:2048 sc1
    v_mov_b32 v4, 0
    s_waitcnt vmcnt(14)
    v_mfma_f32_32x32x16_bf16 v[136:151], v[128:131], v[8:11], 0
    v_max3_u32 v4, v4, v8, v9
    v_max3_u32 v4, v4, v10, v11
    v_max3_u32 v4, v4, v12, v13
    v_max3_u32 v4, v4, v14, v15
    s_waitcnt vmcnt(12)
    v_mfma_f32_32x32x16_bf16 v[136:151], v[120:123], v[16:19], v[136:151]
    v_max3_u32 v4, v4, v16, v17
    v_max3_u32 v4, v4, v18, v19
    v_max3_u32 v4, v4, v20, v21
    v_max3_u32 v4, v4, v22, v23
    s_waitcnt vmcnt(10)
    v_mfma_f32_32x32x16_bf16 v[136:151], v[112:115], v[24:27], v[136:151]
    v_max3_u32 v4, v4, v24, v25
    v_max3_u32 v4, v4, v26, v27
    v_max3_u32 v4, v4, v28, v29
    v_max3_u32 v4, v4, v30, v31
    s_waitcnt vmcnt(8)
    v_mfma_f32_32x32x16_bf16 v[136:151], v[104:107], v[32:35], v[136:151]
    v_max3_u32 v4, v4, v32, v33
    v_max3_u32 v4, v4, v34, v35
    v_max3_u32 v4, v4, v36, v37
    v_max3_u32 v4, v4, v38, v39
    s_waitcnt vmcnt(6)
    v_mfma_f32_32x32x16_bf16 v[136:151], v[80:83], v[40:43], v[136:151]
    v_max3_u32 v4, v4, v40, v41
    v_max3_u32 v4, v4, v42, v43
    v_max3_u32 v4, v4, v44, v45
    v_max3_u32 v4, v4, v46, v47
    s_waitcnt vmcnt(4)
    v_mfma_f32_32x32x16_bf16 v[136:151], v[72:75], v[48:51], v[136:151]
    v_max3_u32 v4, v4, v48, v49
    v_max3_u32 v4, v4, v50, v51
    v_max3_u32 v4, v4, v52, v53
    v_max3_u32 v4, v4, v54, v55
    s_waitcnt vmcnt(2)
    v_mfma_f32_32x32x16_bf16 v[136:151], v[96:99], v[56:59], v[136:151]
    v_max3_u32 v4, v4, v56, v57
    v_max3_u32 v4, v4, v58, v59
    v_max3_u32 v4, v4, v60, v61
    v_max3_u32 v4, v4, v62, v63
    s_waitcnt vmcnt(0)
    v_mfma_f32_32x32x16_bf16 v[136:151], v[88:91], v[64:67], v[136:151]
    v_max3_u32 v4, v4, v64, v65
    v_max3_u32 v4, v4, v66, v67
    v_max3_u32 v4, v4, v68, v69
    v_max3_u32 v4, v4, v70, v71
    v_cmp_eq_u32 vcc, -1, v4
    s_cbranch_vccnz Lor0
    v_mfma_f32_32x32x16_bf16 v[152:167], v[132:135], v[8:11], 0
    s_nop 3
    v_mfma_f32_32x32x16_bf16 v[152:167], v[124:127], v[16:19], v[152:167]
    s_nop 3
    v_mfma_f32_32x32x16_bf16 v[152:167], v[116:119], v[24:27], v[152:167]
    v_mfma_f32_32x32x16_bf16 v[152:167], v[108:111], v[32:35], v[152:167]
    ds_write_b128 v238, v[136:139] offset:0
    v_mfma_f32_32x32x16_bf16 v[152:167], v[84:87], v[40:43], v[152:167]
    ds_write_b128 v238, v[140:143] offset:1056
    v_mfma_f32_32x32x16_bf16 v[152:167], v[76:79], v[48:51], v[152:167]
    ds_write_b128 v238, v[144:147] offset:8512
    v_mfma_f32_32x32x16_bf16 v[152:167], v[100:103], v[56:59], v[152:167]
    ds_write_b128 v238, v[148:151] offset:9568
    v_mfma_f32_32x32x16_bf16 v[152:167], v[92:95], v[64:67], v[152:167]
    v_mfma_f32_32x32x16_bf16 v[168:183], v[128:131], v[12:15], 0
    s_nop 3
    v_mfma_f32_32x32x16_bf16 v[168:183], v[120:123], v[20:23], v[168:183]
    s_nop 3
    v_mfma_f32_32x32x16_bf16 v[168:183], v[112:115], v[28:31], v[168:183]
    v_mfma_f32_32x32x16_bf16 v[168:183], v[104:107], v[36:39], v[168:183]
    ds_write_b128 v238, v[152:155] offset:17024
    v_mfma_f32_32x32x16_bf16 v[168:183], v[80:83], v[44:47], v[168:183]
    ds_write_b128 v238, v[156:159] offset:18080
    v_mfma_f32_32x32x16_bf16 v[168:183], v[72:75], v[52:55], v[168:183]
    ds_write_b128 v238, v[160:163] offset:25536
    v_mfma_f32_32x32x16_bf16 v[168:183], v[96:99], v[60:63], v[168:183]
    ds_write_b128 v238, v[164:167] offset:26592
    v_mfma_f32_32x32x16_bf16 v[168:183], v[88:91], v[68:71], v[168:183]
    v_mfma_f32_32x32x16_bf16 v[184:199], v[132:135], v[12:15], 0
    s_nop 3
    v_mfma_f32_32x32x16_bf16 v[184:199], v[124:127], v[20:23], v[184:199]
    s_nop 3
    v_mfma_f32_32x32x16_bf16 v[184:199], v[116:119], v[28:31], v[184:199]
    v_mfma_f32_32x32x16_bf16 v[184:199], v[108:111], v[36:39], v[184:199]
    ds_write_b128 v239, v[168:171] offset:0
    v_mfma_f32_32x32x16_bf16 v[184:199], v[84:87], v[44:47], v[184:199]
    ds_write_b128 v239, v[172:175] offset:1056
    v_mfma_f32_32x32x16_bf16 v[184:199], v[76:79], v[52:55], v[184:199]
    ds_write_b128 v239, v[176:179] offset:8512
    v_mfma_f32_32x32x16_bf16 v[184:199], v[100:103], v[60:63], v[184:199]
    ds_write_b128 v239, v[180:183] offset:9568
    v_mfma_f32_32x32x16_bf16 v[184:199], v[92:95], v[68:71], v[184:199]
    s_nop 11
    ds_write_b128 v239, v[184:187] offset:17024
    ds_write_b128 v239, v[188:191] offset:18080
    ds_write_b128 v239, v[192:195] offset:25536
    ds_write_b128 v239, v[196:199] offset:26592
Lsd:
    s_waitcnt lgkmcnt(0)
    s_barrier
    s_endpgm
Lor0:
    s_nop 8
    v_mov_b64 v[136:137], 0
    v_mov_b64 v[138:139], 0
    v_mov_b64 v[140:141], 0
    v_mov_b64 v[142:143], 0
    v_mov_b64 v[144:145], 0
    v_mov_b64 v[146:147], 0
    v_mov_b64 v[148:149], 0
    v_mov_b64 v[150:151], 0
    v_mov_b64 v[152:153], 0
    v_mov_b64 v[154:155], 0
    v_mov_b64 v[156:157], 0
    v_mov_b64 v[158:159], 0
    v_mov_b64 v[160:161], 0
    v_mov_b64 v[162:163], 0
    v_mov_b64 v[164:165], 0
    v_mov_b64 v[166:167], 0
    v_mov_b64 v[168:169], 0
    v_mov_b64 v[170:171], 0
    v_mov_b64 v[172:173], 0
    v_mov_b64 v[174:175], 0
    v_mov_b64 v[176:177], 0
    v_mov_b64 v[178:179], 0
    v_mov_b64 v[180:181], 0
    v_mov_b64 v[182:183], 0
    v_mov_b64 v[184:185], 0
    v_mov_b64 v[186:187], 0
    v_mov_b64 v[188:189], 0
    v_mov_b64 v[190:191], 0
    v_mov_b64 v[192:193], 0
    v_mov_b64 v[194:195], 0
    v_mov_b64 v[196:197], 0
    v_mov_b64 v[198:199], 0
    s_mov_b32 s57, 0
    s_mov_b32 s55, 0xff
    s_mov_b32 s58, -1
    s_branch Lor2
Lor:
    s_sleep 4
    s_bitcmp1_b32 s55, 7
    s_cbranch_scc0 Lorn7
    buffer_load_dwordx4 v[8:11], v244, s[40:43], s72 offen offset:3072 sc1
    buffer_load_dwordx4 v[12:15], v244, s[40:43], s81 offen offset:3072 sc1
Lorn7:
    s_bitcmp1_b32 s55, 6
    s_cbranch_scc0 Lorn6
    buffer_load_dwordx4 v[16:19], v244, s[40:43], s72 offen offset:2048 sc1
    buffer_load_dwordx4 v[20:23], v244, s[40:43], s81 offen offset:2048 sc1
Lorn6:
    s_bitcmp1_b32 s55, 5
    s_cbranch_scc0 Lorn5
    buffer_load_dwordx4 v[24:27], v244, s[40:43], s72 offen offset:1024 sc1
    buffer_load_dwordx4 v[28:31], v244, s[40:43], s81 offen offset:1024 sc1
Lorn5:
    s_bitcmp1_b32 s55, 4
    s_cbranch_scc0 Lorn4
    buffer_load_dwordx4 v[32:35], v244, s[40:43], s72 offen offset:0 sc1
    buffer_load_dwordx4 v[36:39], v244, s[40:43], s81 offen offset:0 sc1
Lorn4:
    s_bitcmp1_b32 s55, 1
    s_cbranch_scc0 Lorn1
    buffer_load_dwordx4 v[40:43], v244, s[40:43], s71 offen offset:1024 sc1
    buffer_load_dwordx4 v[44:47], v244, s[40:43], s80 offen offset:1024 sc1
Lorn1:
    s_bitcmp1_b32 s55, 0
    s_cbranch_scc0 Lorn0
    buffer_load_dwordx4 v[48:51], v244, s[40:43], s71 offen offset:0 sc1
    buffer_load_dwordx4 v[52:55], v244, s[40:43], s80 offen offset:0 sc1
Lorn0:
    s_bitcmp1_b32 s55, 3
    s_cbranch_scc0 Lorn3
    buffer_load_dwordx4 v[56:59], v244, s[40:43], s71 offen offset:3072 sc1
    buffer_load_dwordx4 v[60:63], v244, s[40:43], s80 offen offset:3072 sc1
Lorn3:
    s_bitcmp1_b32 s55, 2
    s_cbranch_scc0 Lorn2
    buffer_load_dwordx4 v[64:67], v244, s[40:43], s71 offen offset:2048 sc1
    buffer_load_dwordx4 v[68:71], v244, s[40:43], s80 offen offset:2048 sc1
Lorn2:
    s_add_u32 s57, s57, 1
    s_cmp_ge_u32 s57, 200000
    s_cbranch_scc1 Lod
    s_waitcnt vmcnt(0)
Lor2:
    s_bitcmp1_b32 s55, 7
    s_cbranch_scc0 Lonb7
    v_max3_u32 v4, v8, v9, v10
    v_max3_u32 v4, v4, v11, v12
    v_max3_u32 v4, v4, v13, v14
    v_max_u32 v4, v4, v15
    v_cmp_eq_u32 vcc, s58, v4
    s_cbranch_vccnz Lonb7
    s_bitset0_b32 s55, 7
    v_mfma_f32_32x32x16_bf16 v[136:151], v[128:131], v[8:11], v[136:151]
    v_mfma_f32_32x32x16_bf16 v[152:167], v[132:135], v[8:11], v[152:167]
    v_mfma_f32_32x32x16_bf16 v[168:183], v[128:131], v[12:15], v[168:183]
    v_mfma_f32_32x32x16_bf16 v[184:199], v[132:135], v[12:15], v[184:199]
Lonb7:
    s_bitcmp1_b32 s55, 6
    s_cbranch_scc0 Lonb6
    v_max3_u32 v4, v16, v17, v18
    v_max3_u32 v4, v4, v19, v20
    v_max3_u32 v4, v4, v21, v22
    v_max_u32 v4, v4, v23
    v_cmp_eq_u32 vcc, s58, v4
    s_cbranch_vccnz Lonb6
    s_bitset0_b32 s55, 6
    v_mfma_f32_32x32x16_bf16 v[136:151], v[120:123], v[16:19], v[136:151]
    v_mfma_f32_32x32x16_bf16 v[152:167], v[124:127], v[16:19], v[152:167]
    v_mfma_f32_32x32x16_bf16 v[168:183], v[120:123], v[20:23], v[168:183]
    v_mfma_f32_32x32x16_bf16 v[184:199], v[124:127], v[20:23], v[184:199]
Lonb6:
    s_bitcmp1_b32 s55, 5
    s_cbranch_scc0 Lonb5
    v_max3_u32 v4, v24, v25, v26
    v_max3_u32 v4, v4, v27, v28
    v_max3_u32 v4, v4, v29, v30
    v_max_u32 v4, v4, v31
    v_cmp_eq_u32 vcc, s58, v4
    s_cbranch_vccnz Lonb5
    s_bitset0_b32 s55, 5
    v_mfma_f32_32x32x16_bf16 v[136:151], v[112:115], v[24:27], v[136:151]
    v_mfma_f32_32x32x16_bf16 v[152:167], v[116:119], v[24:27], v[152:167]
    v_mfma_f32_32x32x16_bf16 v[168:183], v[112:115], v[28:31], v[168:183]
    v_mfma_f32_32x32x16_bf16 v[184:199], v[116:119], v[28:31], v[184:199]
Lonb5:
    s_bitcmp1_b32 s55, 4
    s_cbranch_scc0 Lonb4
    v_max3_u32 v4, v32, v33, v34
    v_max3_u32 v4, v4, v35, v36
    v_max3_u32 v4, v4, v37, v38
    v_max_u32 v4, v4, v39
    v_cmp_eq_u32 vcc, s58, v4
    s_cbranch_vccnz Lonb4
    s_bitset0_b32 s55, 4
    v_mfma_f32_32x32x16_bf16 v[136:151], v[104:107], v[32:35], v[136:151]
    v_mfma_f32_32x32x16_bf16 v[152:167], v[108:111], v[32:35], v[152:167]
    v_mfma_f32_32x32x16_bf16 v[168:183], v[104:107], v[36:39], v[168:183]
    v_mfma_f32_32x32x16_bf16 v[184:199], v[108:111], v[36:39], v[184:199]
Lonb4:
    s_bitcmp1_b32 s55, 1
    s_cbranch_scc0 Lonb1
    v_max3_u32 v4, v40, v41, v42
    v_max3_u32 v4, v4, v43, v44
    v_max3_u32 v4, v4, v45, v46
    v_max_u32 v4, v4, v47
    v_cmp_eq_u32 vcc, s58, v4
    s_cbranch_vccnz Lonb1
    s_bitset0_b32 s55, 1
    v_mfma_f32_32x32x16_bf16 v[136:151], v[80:83], v[40:43], v[136:151]
    v_mfma_f32_32x32x16_bf16 v[152:167], v[84:87], v[40:43], v[152:167]
    v_mfma_f32_32x32x16_bf16 v[168:183], v[80:83], v[44:47], v[168:183]
    v_mfma_f32_32x32x16_bf16 v[184:199], v[84:87], v[44:47], v[184:199]
Lonb1:
    s_bitcmp1_b32 s55, 0
    s_cbranch_scc0 Lonb0
    v_max3_u32 v4, v48, v49, v50
    v_max3_u32 v4, v4, v51, v52
    v_max3_u32 v4, v4, v53, v54
    v_max_u32 v4, v4, v55
    v_cmp_eq_u32 vcc, s58, v4
    s_cbranch_vccnz Lonb0
    s_bitset0_b32 s55, 0
    v_mfma_f32_32x32x16_bf16 v[136:151], v[72:75], v[48:51], v[136:151]
    v_mfma_f32_32x32x16_bf16 v[152:167], v[76:79], v[48:51], v[152:167]
    v_mfma_f32_32x32x16_bf16 v[168:183], v[72:75], v[52:55], v[168:183]
    v_mfma_f32_32x32x16_bf16 v[184:199], v[76:79], v[52:55], v[184:199]
Lonb0:
    s_bitcmp1_b32 s55, 3
    s_cbranch_scc0 Lonb3
    v_max3_u32 v4, v56, v57, v58
    v_max3_u32 v4, v4, v59, v60
    v_max3_u32 v4, v4, v61, v62
    v_max_u32 v4, v4, v63
    v_cmp_eq_u32 vcc, s58, v4
    s_cbranch_vccnz Lonb3
    s_bitset0_b32 s55, 3
    v_mfma_f32_32x32x16_bf16 v[136:151], v[96:99], v[56:59], v[136:151]
    v_mfma_f32_32x32x16_bf16 v[152:167], v[100:103], v[56:59], v[152:167]
    v_mfma_f32_32x32x16_bf16 v[168:183], v[96:99], v[60:63], v[168:183]
    v_mfma_f32_32x32x16_bf16 v[184:199], v[100:103], v[60:63], v[184:199]
Lonb3:
    s_bitcmp1_b32 s55, 2
    s_cbranch_scc0 Lonb2
    v_max3_u32 v4, v64, v65, v66
    v_max3_u32 v4, v4, v67, v68
    v_max3_u32 v4, v4, v69, v70
    v_max_u32 v4, v4, v71
    v_cmp_eq_u32 vcc, s58, v4
    s_cbranch_vccnz Lonb2
    s_bitset0_b32 s55, 2
    v_mfma_f32_32x32x16_bf16 v[136:151], v[88:91], v[64:67], v[136:151]
    v_mfma_f32_32x32x16_bf16 v[152:167], v[92:95], v[64:67], v[152:167]
    v_mfma_f32_32x32x16_bf16 v[168:183], v[88:91], v[68:71], v[168:183]
    v_mfma_f32_32x32x16_bf16 v[184:199], v[92:95], v[68:71], v[184:199]
Lonb2:
    s_cmp_lg_u32 s55, 0
    s_cbranch_scc1 Lor
Lod:
    s_nop 6
    ds_write_b128 v238, v[136:139] offset:0
    ds_write_b128 v238, v[140:143] offset:1056
    ds_write_b128 v238, v[144:147] offset:8512
    ds_write_b128 v238, v[148:151] offset:9568
    ds_write_b128 v238, v[152:155] offset:17024
    ds_write_b128 v238, v[156:159] offset:18080
    ds_write_b128 v238, v[160:163] offset:25536
    ds_write_b128 v238, v[164:167] offset:26592
    ds_write_b128 v239, v[168:171] offset:0
    ds_write_b128 v239, v[172:175] offset:1056
    ds_write_b128 v239, v[176:179] offset:8512
    ds_write_b128 v239, v[180:183] offset:9568
    ds_write_b128 v239, v[184:187] offset:17024
    ds_write_b128 v239, v[188:191] offset:18080
    ds_write_b128 v239, v[192:195] offset:25536
    ds_write_b128 v239, v[196:199] offset:26592
    s_branch Lsd
Lfallback0:
    s_cmp_lg_u32 s63, 0
    s_cbranch_scc1 Lok0
    s_mov_b32 s63, 1
    s_mov_b32 s55, 0
    v_mov_b32 v4, 0xff800000
    s_waitcnt lgkmcnt(0)
Lfb10:
    buffer_load_dwordx4 v[16:19], v244, s[40:43], s55 offen sc1
    s_waitcnt vmcnt(0)
    v_mfma_f32_32x32x16_bf16 v[40:55], v[16:19], v[8:11], 0
    s_nop 11
    v_max3_f32 v4, v4, v40, v41
    v_max3_f32 v4, v4, v42, v43
    v_max3_f32 v4, v4, v44, v45
    v_max3_f32 v4, v4, v46, v47
    v_max3_f32 v4, v4, v48, v49
    v_max3_f32 v4, v4, v50, v51
    v_max3_f32 v4, v4, v52, v53
    v_max3_f32 v4, v4, v54, v55
    s_add_u32 s55, s55, 2080
    s_cmp_lt_u32 s55, 133120
    s_cbranch_scc1 Lfb10
    v_mov_b32 v5, v4
    s_nop 1
    v_permlane32_swap_b32 v4, v5
    s_nop 1
    v_max_f32 v4, v4, v5
    v_sub_f32 v72, 0, v4
    v_sub_f32 v73, 0, v4
    v_sub_f32 v74, 0, v4
    v_sub_f32 v75, 0, v4
    v_sub_f32 v76, 0, v4
    v_sub_f32 v77, 0, v4
    v_sub_f32 v78, 0, v4
    v_sub_f32 v79, 0, v4
    v_sub_f32 v80, 0, v4
    v_sub_f32 v81, 0, v4
    v_sub_f32 v82, 0, v4
    v_sub_f32 v83, 0, v4
    v_sub_f32 v84, 0, v4
    v_sub_f32 v85, 0, v4
    v_sub_f32 v86, 0, v4
    v_sub_f32 v87, 0, v4
    v_mov_b32 v104, 0
    v_mov_b32 v105, 0
    v_mov_b32 v106, 0
    v_mov_b32 v107, 0
    v_mov_b32 v108, 0
    v_mov_b32 v109, 0
    v_mov_b32 v110, 0
    v_mov_b32 v111, 0
    v_mov_b32 v112, 0
    v_mov_b32 v113, 0
    v_mov_b32 v114, 0
    v_mov_b32 v115, 0
    v_subrev_u32 v3, 133120, v242
    s_mov_b32 s55, 0
Lfb20:
    buffer_load_dwordx4 v[16:19], v244, s[40:43], s55 offen sc1
    buffer_load_dwordx4 v[24:27], v3, s[40:43], s55 offen sc1
    buffer_load_dwordx4 v[32:35], v3, s[40:43], s55 offen offset:528 sc1
    s_waitcnt vmcnt(0)
    v_mfma_f32_32x32x16_bf16 v[40:55], v[16:19], v[8:11], v[72:87]
    s_nop 11
    v_exp_f32 v40, v40
    v_exp_f32 v41, v41
    v_exp_f32 v42, v42
    v_exp_f32 v43, v43
    v_exp_f32 v44, v44
    v_exp_f32 v45, v45
    v_exp_f32 v46, v46
    v_exp_f32 v47, v47
    v_exp_f32 v48, v48
    v_exp_f32 v49, v49
    v_exp_f32 v50, v50
    v_exp_f32 v51, v51
    v_exp_f32 v52, v52
    v_exp_f32 v53, v53
    v_exp_f32 v54, v54
    v_exp_f32 v55, v55
    s_nop 1
    v_smfmac_f32_32x32x32_bf16 v[104:119], v[24:27], v[40:47], v240
    v_smfmac_f32_32x32x32_bf16 v[104:119], v[32:35], v[48:55], v240
    s_add_u32 s55, s55, 2080
    s_cmp_lt_u32 s55, 133120
    s_cbranch_scc1 Lfb20
    s_nop 9
    s_branch Lfin0
Lfallback1:
    s_cmp_lg_u32 s63, 0
    s_cbranch_scc1 Lok1
    s_mov_b32 s63, 1
    s_mov_b32 s55, 0
    v_mov_b32 v4, 0xff800000
    s_waitcnt lgkmcnt(0)
Lfb11:
    buffer_load_dwordx4 v[16:19], v244, s[40:43], s55 offen sc1
    s_waitcnt vmcnt(0)
    v_mfma_f32_32x32x16_bf16 v[40:55], v[16:19], v[12:15], 0
    s_nop 11
    v_max3_f32 v4, v4, v40, v41
    v_max3_f32 v4, v4, v42, v43
    v_max3_f32 v4, v4, v44, v45
    v_max3_f32 v4, v4, v46, v47
    v_max3_f32 v4, v4, v48, v49
    v_max3_f32 v4, v4, v50, v51
    v_max3_f32 v4, v4, v52, v53
    v_max3_f32 v4, v4, v54, v55
    s_add_u32 s55, s55, 2080
    s_cmp_lt_u32 s55, 133120
    s_cbranch_scc1 Lfb11
    v_mov_b32 v5, v4
    s_nop 1
    v_permlane32_swap_b32 v4, v5
    s_nop 1
    v_max_f32 v4, v4, v5
    v_sub_f32 v88, 0, v4
    v_sub_f32 v89, 0, v4
    v_sub_f32 v90, 0, v4
    v_sub_f32 v91, 0, v4
    v_sub_f32 v92, 0, v4
    v_sub_f32 v93, 0, v4
    v_sub_f32 v94, 0, v4
    v_sub_f32 v95, 0, v4
    v_sub_f32 v96, 0, v4
    v_sub_f32 v97, 0, v4
    v_sub_f32 v98, 0, v4
    v_sub_f32 v99, 0, v4
    v_sub_f32 v100, 0, v4
    v_sub_f32 v101, 0, v4
    v_sub_f32 v102, 0, v4
    v_sub_f32 v103, 0, v4
    v_mov_b32 v120, 0
    v_mov_b32 v121, 0
    v_mov_b32 v122, 0
    v_mov_b32 v123, 0
    v_mov_b32 v124, 0
    v_mov_b32 v125, 0
    v_mov_b32 v126, 0
    v_mov_b32 v127, 0
    v_mov_b32 v128, 0
    v_mov_b32 v129, 0
    v_mov_b32 v130, 0
    v_mov_b32 v131, 0
    v_subrev_u32 v3, 133120, v242
    s_mov_b32 s55, 0
Lfb21:
    buffer_load_dwordx4 v[16:19], v244, s[40:43], s55 offen sc1
    buffer_load_dwordx4 v[24:27], v3, s[40:43], s55 offen sc1
    buffer_load_dwordx4 v[32:35], v3, s[40:43], s55 offen offset:528 sc1
    s_waitcnt vmcnt(0)
    v_mfma_f32_32x32x16_bf16 v[40:55], v[16:19], v[12:15], v[88:103]
    s_nop 11
    v_exp_f32 v40, v40
    v_exp_f32 v41, v41
    v_exp_f32 v42, v42
    v_exp_f32 v43, v43
    v_exp_f32 v44, v44
    v_exp_f32 v45, v45
    v_exp_f32 v46, v46
    v_exp_f32 v47, v47
    v_exp_f32 v48, v48
    v_exp_f32 v49, v49
    v_exp_f32 v50, v50
    v_exp_f32 v51, v51
    v_exp_f32 v52, v52
    v_exp_f32 v53, v53
    v_exp_f32 v54, v54
    v_exp_f32 v55, v55
    s_nop 1
    v_smfmac_f32_32x32x32_bf16 v[120:135], v[24:27], v[40:47], v240
    v_smfmac_f32_32x32x32_bf16 v[120:135], v[32:35], v[48:55], v240
    s_add_u32 s55, s55, 2080
    s_cmp_lt_u32 s55, 133120
    s_cbranch_scc1 Lfb21
    s_nop 9
    s_branch Lfin1
Lcodeend:
.section .rodata,"a"
.p2align 6
.amdhsa_kernel recurrent_scan__grouped_kv_mqa__geglu_ffn__prompt_kernel
  .amdhsa_next_free_vgpr 256
  .amdhsa_next_free_sgpr 102
  .amdhsa_accum_offset 256
  .amdhsa_group_segment_fixed_size 0
  .amdhsa_kernarg_size 96
  .amdhsa_user_sgpr_count 2
  .amdhsa_user_sgpr_kernarg_segment_ptr 1
  .amdhsa_system_sgpr_workgroup_id_x 1
.end_amdhsa_kernel
```
